```python
import torch

def _softmax(x, axis=-1):
    return torch.softmax(x, dim=axis)

def _gelu(x):
    return torch.nn.functional.gelu(x, approximate='tanh')

def _silu(x):
    return torch.nn.functional.silu(x)

def _sigmoid(x):
    return torch.sigmoid(x)

def _layernorm(x, axis=-1, eps=1e-05):
    m = x.mean(dim=axis, keepdim=True)
    v = x.var(dim=axis, keepdim=True, unbiased=False)
    return (x - m) / torch.sqrt(v + eps)

def _scatter_add(tgt, idx, src, axis=0):
    return tgt.clone().index_add_(axis, idx, src)

def _segment_sum(src, seg, n):
    out = torch.zeros((n,) + src.shape[1:], dtype=src.dtype)
    return out.index_add_(0, seg, src)

def _pad(x, pw):
    flat = tuple((v for pair in reversed(pw) for v in pair))
    return torch.nn.functional.pad(x, flat)
kernel_name = 'adaLN_cond__ssm_conv_s4__moe_arch_mod__prompt'

def setup_inputs():

    _w = lambda a: (lambda t: t.to(torch.bfloat16) if t.is_floating_point() else t)(torch.as_tensor(a))

    def _A_setup():
        B, L, D, N = (1, 2048, 448, 256)
        A_re = -(lambda _x: torch.exp(torch.as_tensor(_x)))((lambda *s: torch.randn(*s, dtype=torch.bfloat16) * 12.8)(D, N))
        A_im = torch.pi * (lambda *s: torch.randn(*s, dtype=torch.bfloat16) * 0.05)(D, N)
        B_re = (lambda *s: torch.randn(*s, dtype=torch.bfloat16) * 0.1)(D, N)
        B_im = (lambda *s: torch.randn(*s, dtype=torch.bfloat16) * 0.1)(D, N)
        C_re = (lambda *s: torch.randn(*s, dtype=torch.bfloat16) * 0.1)(D, N)
        C_im = (lambda *s: torch.randn(*s, dtype=torch.bfloat16) * 0.1)(D, N)
        log_dt = (lambda *s: torch.randn(*s, dtype=torch.bfloat16) * 0.05)(D) * 0.5 - 4.0
        Dskip = (lambda *s: torch.randn(*s, dtype=torch.bfloat16) * 0.05)(D)
        return {'u': _w((lambda *s: torch.randn(*s, dtype=torch.bfloat16) * 0.05)(B, L, D)), 'A_re': _w(A_re), 'A_im': _w(A_im), 'B_re': _w(B_re), 'B_im': _w(B_im), 'C_re': _w(C_re), 'C_im': _w(C_im), 'log_dt': _w(log_dt), 'Dskip': _w(Dskip)}
    _A_in = _A_setup()

    def _B_setup():
        B, S, D, F, C = (1, 2048, 448, 1792, 8)
        return {'x': _w((lambda *s: torch.randn(*s, dtype=torch.bfloat16) * 0.05)(B, S, D)), 'w_r': _w((lambda *s: torch.randn(*s, dtype=torch.bfloat16) * 0.05)(D)), 'w_gate': _w((lambda *s: torch.randn(*s, dtype=torch.bfloat16) * 0.05)(D, F)), 'w_up': _w((lambda *s: torch.randn(*s, dtype=torch.bfloat16) * 0.05)(D, F)), 'w_down': _w((lambda *s: torch.randn(*s, dtype=torch.bfloat16) * 0.05)(F, D))}
    _B_in = _B_setup()
    return {'A_u': _A_in['u'], 'A_A_re': _A_in['A_re'], 'A_A_im': _A_in['A_im'], 'A_B_re': _A_in['B_re'], 'A_B_im': _A_in['B_im'], 'A_C_re': _A_in['C_re'], 'A_C_im': _A_in['C_im'], 'A_log_dt': _A_in['log_dt'], 'A_Dskip': _A_in['Dskip'], 'B_x': _B_in['x'], 'B_w_r': _B_in['w_r'], 'B_w_gate': _B_in['w_gate'], 'B_w_up': _B_in['w_up'], 'B_w_down': _B_in['w_down'], 'c': _w((lambda *s: torch.randn(*s, dtype=torch.bfloat16) * 0.1)(1, 448) * 8.0), 'w_mod': _w((lambda *s: torch.randn(*s, dtype=torch.bfloat16) * 0.1)(448, 6 * 448) * 448 ** (-0.5) * 8.0)}

def reference(A_u, A_A_re, A_A_im, A_B_re, A_B_im, A_C_re, A_C_im, A_log_dt, A_Dskip, B_x, B_w_r, B_w_gate, B_w_up, B_w_down, c, w_mod):

    def _A_ref(u, A_re, A_im, B_re, B_im, C_re, C_im, log_dt, Dskip):
        Bsz, L, D = u.shape
        dt = torch.exp(log_dt)[:, None]
        A = A_re + 1j * A_im
        Bc = B_re + 1j * B_im
        Cc = C_re + 1j * C_im
        logdA = dt * A
        dB = dt * Bc
        l = (lambda x, dt: x.to(dt))(torch.arange(L), A_re.dtype)
        P = torch.exp(logdA[:, :, None] * l[None, None, :])
        K = torch.einsum('dn,dnl,dn->dl', Cc, P, dB).real
        L2 = 2 * L
        Kp = _pad(K, ((0, 0), (0, L)))
        up = (lambda x, *d: x.permute(*d))(u, 0, 2, 1)
        up = _pad(up, ((0, 0), (0, 0), (0, L)))
        Kf = (lambda x, axes=(-2, -1): torch.fft.rfft2(x.float(), dim=axes))(Kp[:, None, :], axes=(-2, -1))
        Uf = (lambda x, axes=(-2, -1): torch.fft.rfft2(x.float(), dim=axes))(up[:, :, None, :], axes=(-2, -1))
        Yf = Uf * Kf[None, :, :, :]
        y = (lambda x, s, axes=(-2, -1): torch.fft.irfft2(x, s=s, dim=axes).to(torch.bfloat16))(Yf, (1, L2), axes=(-2, -1))[:, :, 0, :L]
        y = (lambda x, *d: x.permute(*d))(y, 0, 2, 1) + u * Dskip[None, None, :]
        return y

    def _B_ref(x, w_r, w_gate, w_up, w_down):
        B, S, D = x.shape
        C = 8
        r = x @ w_r
        idx = torch.argsort(-r, axis=-1)[:, :C]
        idx_e = (lambda x, n, axis: torch.repeat_interleave(x, n, dim=axis))(idx.reshape(B, C, 1), D, axis=2)
        x_sel = (lambda x, i, axis: torch.take_along_dim(x, i, dim=axis))(x, idx_e, axis=1)
        g = _silu(x_sel @ w_gate)
        u = x_sel @ w_up
        y = g * u @ w_down
        r_sel = _sigmoid((lambda x, i, axis: torch.take_along_dim(x, i, dim=axis))(r, idx, axis=1))
        y = y * r_sel.reshape(B, C, 1)
        b_off = (torch.arange(B) * S).reshape(B, 1)
        flat_idx = (idx + b_off).reshape(B * C)
        zero = (x * 0.0).reshape(B * S, D)
        upd = _scatter_add(zero, flat_idx, y.reshape(B * C, D), axis=0)
        return x + upd.reshape(B, S, D)
    x = A_u
    mod = (_silu(c) @ w_mod).reshape(c.shape[0], 6, 1, -1)
    sa, ca, ga, sb, cb, gb = (mod[:, 0].clone(), mod[:, 1].clone(), mod[:, 2].clone(), mod[:, 3].clone(), mod[:, 4].clone(), mod[:, 5].clone())
    h = _layernorm(x, axis=-1) * (1 + ca) + sa
    x = x + ga * _A_ref(h, A_A_re, A_A_im, A_B_re, A_B_im, A_C_re, A_C_im, A_log_dt, A_Dskip)
    h = _layernorm(x, axis=-1) * (1 + cb) + sb
    x = x + gb * _B_ref(h, B_w_r, B_w_gate, B_w_up, B_w_down)
    return x
```

```asm
; @launch kernel=f1_kernel grid=(668,1,1) block=(256,1,1) lds=50320
; @launch kernel=k3_kernel grid=(256,1,1) block=(512,1,1) lds=14336
; @launch kernel=k4_kernel grid=(224,1,1) block=(512,1,1) lds=26368
; @launch kernel=k5_kernel grid=(224,1,1) block=(256,1,1) lds=1024
.amdgcn_target "amdgcn-amd-amdhsa--gfx950"
.text
.globl f1_kernel
.p2align 8
.type f1_kernel,@function
f1_kernel:
    s_load_dwordx16 s[4:19], s[0:1], 0
    s_load_dwordx4 s[20:23], s[0:1], 112
    s_load_dwordx4 s[24:27], s[0:1], 136
    s_cmp_ge_u32 s2, 668
    s_cbranch_scc1 F1_end
    s_cmp_ge_u32 s2, 660
    s_cbranch_scc1 F1_cpf
    s_sub_u32 s42, s2, 576
    s_cmp_ge_u32 s2, 604
    s_cbranch_scc1 F1_lowg
    s_cmp_ge_u32 s2, 156
    s_cbranch_scc1 F1_conv
    s_setprio 3
    s_sub_u32 s42, s2, 128
F1_lowg:
    s_mov_b32 s50, 1835008
    s_mov_b32 s51, 0x20000
    s_mov_b32 s54, 2408448
    s_mov_b32 s55, 0x20000
    s_mov_b32 s58, 896
    s_mov_b32 s59, 0x20000
    s_mov_b32 s34, 268435456
    s_mov_b32 s35, 0x20000
    s_mov_b32 s62, 256
    s_mov_b32 s63, 0x20000
    s_waitcnt lgkmcnt(0)
    s_mov_b64 s[48:49], s[4:5]
    s_mov_b64 s[52:53], s[22:23]
    s_mov_b64 s[56:57], s[20:21]
    s_mov_b64 s[32:33], s[26:27]
    s_mov_b64 s[60:61], s[24:25]
    s_mov_b32 s36, 0x3fb8aa3b
    s_mov_b32 s37, 0x32a57060
    s_mov_b32 s38, 0x3f317218
    s_mov_b32 s3, s2
    s_cmp_ge_u32 s2, 128
    s_cbranch_scc1 F1_gemv
    v_and_b32 v1, 63, v0
    v_lshrrev_b32 v2, 6, v0
    s_mul_i32 s16, s3, 14336
    v_mul_u32_u24 v3, 3584, v2
    v_lshl_add_u32 v3, v1, 4, v3
    v_mov_b32 v96, 0
    v_mov_b32 v97, 0
    v_mov_b32 v98, 0
    v_mov_b32 v99, 0
    v_mov_b32 v100, 0
    v_mov_b32 v101, 0
    v_mov_b32 v102, 0
    v_mov_b32 v103, 0
    v_mov_b32 v104, 0
    v_mov_b32 v105, 0
    v_mov_b32 v106, 0
    v_mov_b32 v107, 0
    v_mov_b32 v108, 0
    v_mov_b32 v109, 0
    v_mov_b32 v110, 0
    v_mov_b32 v111, 0
    s_waitcnt lgkmcnt(0)
    s_mov_b32 exec_hi, 0x00ffffff
    buffer_load_dwordx4 v[96:99], v3, s[48:51], s16 offen offset:0
    buffer_load_dwordx4 v[100:103], v3, s[48:51], s16 offen offset:896
    buffer_load_dwordx4 v[104:107], v3, s[48:51], s16 offen offset:1792
    buffer_load_dwordx4 v[108:111], v3, s[48:51], s16 offen offset:2688
    s_mov_b32 exec_hi, -1
    v_and_b32 v4, 15, v1
    v_lshlrev_b32 v4, 4, v4
    v_lshlrev_b32 v5, 3, v2
    v_xor_b32 v4, v4, v5
    v_lshl_add_u32 v4, v1, 8, v4
    v_lshlrev_b32 v7, 5, v2
    s_lshl_b32 s18, s3, 7
    s_add_u32 s18, s18, 65536
    v_lshlrev_b32 v5, 4, v0
    v_bfe_u32 v6, v0, 4, 4
    v_lshlrev_b32 v6, 4, v6
    v_xor_b32 v6, v6, v5
    s_add_u32 s16, s16, 131072
    s_add_u32 s17, s16, 4096
    s_add_u32 s19, s16, 8192
    s_add_u32 s20, s16, 12288
    s_waitcnt vmcnt(0)
    v_lshlrev_b32 v24, 16, v96
    v_and_b32 v25, 0xffff0000, v96
    v_lshlrev_b32 v26, 16, v97
    v_and_b32 v27, 0xffff0000, v97
    v_lshlrev_b32 v28, 16, v98
    v_and_b32 v29, 0xffff0000, v98
    v_lshlrev_b32 v30, 16, v99
    v_and_b32 v31, 0xffff0000, v99
    v_lshlrev_b32 v32, 16, v100
    v_and_b32 v33, 0xffff0000, v100
    v_lshlrev_b32 v34, 16, v101
    v_and_b32 v35, 0xffff0000, v101
    v_lshlrev_b32 v36, 16, v102
    v_and_b32 v37, 0xffff0000, v102
    v_lshlrev_b32 v38, 16, v103
    v_and_b32 v39, 0xffff0000, v103
    v_lshlrev_b32 v40, 16, v104
    v_and_b32 v41, 0xffff0000, v104
    v_lshlrev_b32 v42, 16, v105
    v_and_b32 v43, 0xffff0000, v105
    v_lshlrev_b32 v44, 16, v106
    v_and_b32 v45, 0xffff0000, v106
    v_lshlrev_b32 v46, 16, v107
    v_and_b32 v47, 0xffff0000, v107
    v_lshlrev_b32 v48, 16, v108
    v_and_b32 v49, 0xffff0000, v108
    v_lshlrev_b32 v50, 16, v109
    v_and_b32 v51, 0xffff0000, v109
    v_lshlrev_b32 v52, 16, v110
    v_and_b32 v53, 0xffff0000, v110
    v_lshlrev_b32 v54, 16, v111
    v_and_b32 v55, 0xffff0000, v111
    v_pk_add_f32 v[84:85], v[24:25], v[26:27]
    v_pk_add_f32 v[86:87], v[28:29], v[30:31]
    v_pk_add_f32 v[84:85], v[84:85], v[86:87]
    v_add_f32 v56, v84, v85
    v_pk_add_f32 v[84:85], v[32:33], v[34:35]
    v_pk_add_f32 v[86:87], v[36:37], v[38:39]
    v_pk_add_f32 v[84:85], v[84:85], v[86:87]
    v_add_f32 v57, v84, v85
    v_pk_add_f32 v[84:85], v[40:41], v[42:43]
    v_pk_add_f32 v[86:87], v[44:45], v[46:47]
    v_pk_add_f32 v[84:85], v[84:85], v[86:87]
    v_add_f32 v58, v84, v85
    v_pk_add_f32 v[84:85], v[48:49], v[50:51]
    v_pk_add_f32 v[86:87], v[52:53], v[54:55]
    v_pk_add_f32 v[84:85], v[84:85], v[86:87]
    v_add_f32 v59, v84, v85
    v_add_f32_dpp v56, v56, v56 row_shr:1 row_mask:0xf bank_mask:0xf bound_ctrl:0
    v_add_f32_dpp v57, v57, v57 row_shr:1 row_mask:0xf bank_mask:0xf bound_ctrl:0
    v_add_f32_dpp v58, v58, v58 row_shr:1 row_mask:0xf bank_mask:0xf bound_ctrl:0
    v_add_f32_dpp v59, v59, v59 row_shr:1 row_mask:0xf bank_mask:0xf bound_ctrl:0
    v_add_f32_dpp v56, v56, v56 row_shr:2 row_mask:0xf bank_mask:0xf bound_ctrl:0
    v_add_f32_dpp v57, v57, v57 row_shr:2 row_mask:0xf bank_mask:0xf bound_ctrl:0
    v_add_f32_dpp v58, v58, v58 row_shr:2 row_mask:0xf bank_mask:0xf bound_ctrl:0
    v_add_f32_dpp v59, v59, v59 row_shr:2 row_mask:0xf bank_mask:0xf bound_ctrl:0
    v_add_f32_dpp v56, v56, v56 row_shr:4 row_mask:0xf bank_mask:0xf bound_ctrl:0
    v_add_f32_dpp v57, v57, v57 row_shr:4 row_mask:0xf bank_mask:0xf bound_ctrl:0
    v_add_f32_dpp v58, v58, v58 row_shr:4 row_mask:0xf bank_mask:0xf bound_ctrl:0
    v_add_f32_dpp v59, v59, v59 row_shr:4 row_mask:0xf bank_mask:0xf bound_ctrl:0
    v_add_f32_dpp v56, v56, v56 row_shr:8 row_mask:0xf bank_mask:0xf bound_ctrl:0
    v_add_f32_dpp v57, v57, v57 row_shr:8 row_mask:0xf bank_mask:0xf bound_ctrl:0
    v_add_f32_dpp v58, v58, v58 row_shr:8 row_mask:0xf bank_mask:0xf bound_ctrl:0
    v_add_f32_dpp v59, v59, v59 row_shr:8 row_mask:0xf bank_mask:0xf bound_ctrl:0
    v_add_f32_dpp v56, v56, v56 row_bcast:15 row_mask:0xa bank_mask:0xf
    v_add_f32_dpp v57, v57, v57 row_bcast:15 row_mask:0xa bank_mask:0xf
    v_add_f32_dpp v58, v58, v58 row_bcast:15 row_mask:0xa bank_mask:0xf
    v_add_f32_dpp v59, v59, v59 row_bcast:15 row_mask:0xa bank_mask:0xf
    v_add_f32_dpp v56, v56, v56 row_bcast:31 row_mask:0xc bank_mask:0xf
    v_add_f32_dpp v57, v57, v57 row_bcast:31 row_mask:0xc bank_mask:0xf
    v_add_f32_dpp v58, v58, v58 row_bcast:31 row_mask:0xc bank_mask:0xf
    v_add_f32_dpp v59, v59, v59 row_bcast:31 row_mask:0xc bank_mask:0xf
    v_readlane_b32 s64, v56, 63
    v_readlane_b32 s65, v57, 63
    v_readlane_b32 s66, v58, 63
    v_readlane_b32 s67, v59, 63
    v_mov_b32 v88, 0x3b124925
    v_mul_f32 v60, s64, v88
    v_mul_f32 v66, s65, v88
    v_mul_f32 v72, s66, v88
    v_mul_f32 v78, s67, v88
    v_mov_b32 v56, 0
    v_mov_b32 v57, 0
    v_mov_b32 v58, 0
    v_mov_b32 v59, 0
    s_mov_b32 exec_hi, 0x00ffffff
    v_pk_add_f32 v[84:85], v[24:25], v[60:61] op_sel:[0,0] op_sel_hi:[1,0] neg_lo:[0,1] neg_hi:[0,1]
    v_pk_add_f32 v[86:87], v[26:27], v[60:61] op_sel:[0,0] op_sel_hi:[1,0] neg_lo:[0,1] neg_hi:[0,1]
    v_pk_mul_f32 v[62:63], v[84:85], v[84:85]
    v_pk_fma_f32 v[62:63], v[86:87], v[86:87], v[62:63]
    v_pk_add_f32 v[84:85], v[28:29], v[60:61] op_sel:[0,0] op_sel_hi:[1,0] neg_lo:[0,1] neg_hi:[0,1]
    v_pk_add_f32 v[86:87], v[30:31], v[60:61] op_sel:[0,0] op_sel_hi:[1,0] neg_lo:[0,1] neg_hi:[0,1]
    v_pk_fma_f32 v[62:63], v[84:85], v[84:85], v[62:63]
    v_pk_fma_f32 v[62:63], v[86:87], v[86:87], v[62:63]
    v_add_f32 v56, v62, v63
    v_pk_add_f32 v[84:85], v[32:33], v[66:67] op_sel:[0,0] op_sel_hi:[1,0] neg_lo:[0,1] neg_hi:[0,1]
    v_pk_add_f32 v[86:87], v[34:35], v[66:67] op_sel:[0,0] op_sel_hi:[1,0] neg_lo:[0,1] neg_hi:[0,1]
    v_pk_mul_f32 v[68:69], v[84:85], v[84:85]
    v_pk_fma_f32 v[68:69], v[86:87], v[86:87], v[68:69]
    v_pk_add_f32 v[84:85], v[36:37], v[66:67] op_sel:[0,0] op_sel_hi:[1,0] neg_lo:[0,1] neg_hi:[0,1]
    v_pk_add_f32 v[86:87], v[38:39], v[66:67] op_sel:[0,0] op_sel_hi:[1,0] neg_lo:[0,1] neg_hi:[0,1]
    v_pk_fma_f32 v[68:69], v[84:85], v[84:85], v[68:69]
    v_pk_fma_f32 v[68:69], v[86:87], v[86:87], v[68:69]
    v_add_f32 v57, v68, v69
    v_pk_add_f32 v[84:85], v[40:41], v[72:73] op_sel:[0,0] op_sel_hi:[1,0] neg_lo:[0,1] neg_hi:[0,1]
    v_pk_add_f32 v[86:87], v[42:43], v[72:73] op_sel:[0,0] op_sel_hi:[1,0] neg_lo:[0,1] neg_hi:[0,1]
    v_pk_mul_f32 v[74:75], v[84:85], v[84:85]
    v_pk_fma_f32 v[74:75], v[86:87], v[86:87], v[74:75]
    v_pk_add_f32 v[84:85], v[44:45], v[72:73] op_sel:[0,0] op_sel_hi:[1,0] neg_lo:[0,1] neg_hi:[0,1]
    v_pk_add_f32 v[86:87], v[46:47], v[72:73] op_sel:[0,0] op_sel_hi:[1,0] neg_lo:[0,1] neg_hi:[0,1]
    v_pk_fma_f32 v[74:75], v[84:85], v[84:85], v[74:75]
    v_pk_fma_f32 v[74:75], v[86:87], v[86:87], v[74:75]
    v_add_f32 v58, v74, v75
    v_pk_add_f32 v[84:85], v[48:49], v[78:79] op_sel:[0,0] op_sel_hi:[1,0] neg_lo:[0,1] neg_hi:[0,1]
    v_pk_add_f32 v[86:87], v[50:51], v[78:79] op_sel:[0,0] op_sel_hi:[1,0] neg_lo:[0,1] neg_hi:[0,1]
    v_pk_mul_f32 v[80:81], v[84:85], v[84:85]
    v_pk_fma_f32 v[80:81], v[86:87], v[86:87], v[80:81]
    v_pk_add_f32 v[84:85], v[52:53], v[78:79] op_sel:[0,0] op_sel_hi:[1,0] neg_lo:[0,1] neg_hi:[0,1]
    v_pk_add_f32 v[86:87], v[54:55], v[78:79] op_sel:[0,0] op_sel_hi:[1,0] neg_lo:[0,1] neg_hi:[0,1]
    v_pk_fma_f32 v[80:81], v[84:85], v[84:85], v[80:81]
    v_pk_fma_f32 v[80:81], v[86:87], v[86:87], v[80:81]
    v_add_f32 v59, v80, v81
    s_mov_b32 exec_hi, -1
    s_nop 0
    v_add_f32_dpp v56, v56, v56 row_shr:1 row_mask:0xf bank_mask:0xf bound_ctrl:0
    v_add_f32_dpp v57, v57, v57 row_shr:1 row_mask:0xf bank_mask:0xf bound_ctrl:0
    v_add_f32_dpp v58, v58, v58 row_shr:1 row_mask:0xf bank_mask:0xf bound_ctrl:0
    v_add_f32_dpp v59, v59, v59 row_shr:1 row_mask:0xf bank_mask:0xf bound_ctrl:0
    v_add_f32_dpp v56, v56, v56 row_shr:2 row_mask:0xf bank_mask:0xf bound_ctrl:0
    v_add_f32_dpp v57, v57, v57 row_shr:2 row_mask:0xf bank_mask:0xf bound_ctrl:0
    v_add_f32_dpp v58, v58, v58 row_shr:2 row_mask:0xf bank_mask:0xf bound_ctrl:0
    v_add_f32_dpp v59, v59, v59 row_shr:2 row_mask:0xf bank_mask:0xf bound_ctrl:0
    v_add_f32_dpp v56, v56, v56 row_shr:4 row_mask:0xf bank_mask:0xf bound_ctrl:0
    v_add_f32_dpp v57, v57, v57 row_shr:4 row_mask:0xf bank_mask:0xf bound_ctrl:0
    v_add_f32_dpp v58, v58, v58 row_shr:4 row_mask:0xf bank_mask:0xf bound_ctrl:0
    v_add_f32_dpp v59, v59, v59 row_shr:4 row_mask:0xf bank_mask:0xf bound_ctrl:0
    v_add_f32_dpp v56, v56, v56 row_shr:8 row_mask:0xf bank_mask:0xf bound_ctrl:0
    v_add_f32_dpp v57, v57, v57 row_shr:8 row_mask:0xf bank_mask:0xf bound_ctrl:0
    v_add_f32_dpp v58, v58, v58 row_shr:8 row_mask:0xf bank_mask:0xf bound_ctrl:0
    v_add_f32_dpp v59, v59, v59 row_shr:8 row_mask:0xf bank_mask:0xf bound_ctrl:0
    v_add_f32_dpp v56, v56, v56 row_bcast:15 row_mask:0xa bank_mask:0xf
    v_add_f32_dpp v57, v57, v57 row_bcast:15 row_mask:0xa bank_mask:0xf
    v_add_f32_dpp v58, v58, v58 row_bcast:15 row_mask:0xa bank_mask:0xf
    v_add_f32_dpp v59, v59, v59 row_bcast:15 row_mask:0xa bank_mask:0xf
    v_add_f32_dpp v56, v56, v56 row_bcast:31 row_mask:0xc bank_mask:0xf
    v_add_f32_dpp v57, v57, v57 row_bcast:31 row_mask:0xc bank_mask:0xf
    v_add_f32_dpp v58, v58, v58 row_bcast:31 row_mask:0xc bank_mask:0xf
    v_add_f32_dpp v59, v59, v59 row_bcast:31 row_mask:0xc bank_mask:0xf
    v_readlane_b32 s64, v56, 63
    v_readlane_b32 s65, v57, 63
    v_readlane_b32 s66, v58, 63
    v_readlane_b32 s67, v59, 63
    v_mul_f32 v62, s64, v88
    v_mul_f32 v68, s65, v88
    v_mul_f32 v74, s66, v88
    v_mul_f32 v80, s67, v88
    v_cvt_pk_bf16_f32 v84, v60, v62
    v_lshlrev_b32 v60, 16, v84
    v_and_b32 v62, 0xffff0000, v84
    v_cvt_pk_bf16_f32 v85, v66, v68
    v_lshlrev_b32 v66, 16, v85
    v_and_b32 v68, 0xffff0000, v85
    v_cvt_pk_bf16_f32 v86, v72, v74
    v_lshlrev_b32 v72, 16, v86
    v_and_b32 v74, 0xffff0000, v86
    v_cvt_pk_bf16_f32 v87, v78, v80
    v_lshlrev_b32 v78, 16, v87
    v_and_b32 v80, 0xffff0000, v87
    v_add_f32 v62, 0x3727c5ac, v62
    v_add_f32 v68, 0x3727c5ac, v68
    v_add_f32 v74, 0x3727c5ac, v74
    v_add_f32 v80, 0x3727c5ac, v80
    v_cvt_pk_bf16_f32 v84, v62, v62
    v_lshlrev_b32 v62, 16, v84
    v_cvt_pk_bf16_f32 v85, v68, v68
    v_lshlrev_b32 v68, 16, v85
    v_cvt_pk_bf16_f32 v86, v74, v74
    v_lshlrev_b32 v74, 16, v86
    v_cvt_pk_bf16_f32 v87, v80, v80
    v_lshlrev_b32 v80, 16, v87
    v_sqrt_f32 v62, v62
    v_sqrt_f32 v68, v68
    v_sqrt_f32 v74, v74
    v_sqrt_f32 v80, v80
    v_cvt_pk_bf16_f32 v84, v62, v62
    v_lshlrev_b32 v62, 16, v84
    v_cvt_pk_bf16_f32 v85, v68, v68
    v_lshlrev_b32 v68, 16, v85
    v_cvt_pk_bf16_f32 v86, v74, v74
    v_lshlrev_b32 v74, 16, v86
    v_cvt_pk_bf16_f32 v87, v80, v80
    v_lshlrev_b32 v80, 16, v87
    v_rcp_f32 v64, v62
    v_rcp_f32 v70, v68
    v_rcp_f32 v76, v74
    v_rcp_f32 v82, v80
    v_pk_add_f32 v[24:25], v[24:25], v[60:61] op_sel:[0,0] op_sel_hi:[1,0] neg_lo:[0,1] neg_hi:[0,1]
    v_cvt_pk_bf16_f32 v92, v24, v25
    v_lshlrev_b32 v24, 16, v92
    v_and_b32 v25, 0xffff0000, v92
    v_pk_mul_f32 v[24:25], v[24:25], v[64:65] op_sel:[0,0] op_sel_hi:[1,0]
    v_pk_add_f32 v[26:27], v[26:27], v[60:61] op_sel:[0,0] op_sel_hi:[1,0] neg_lo:[0,1] neg_hi:[0,1]
    v_cvt_pk_bf16_f32 v92, v26, v27
    v_lshlrev_b32 v26, 16, v92
    v_and_b32 v27, 0xffff0000, v92
    v_pk_mul_f32 v[26:27], v[26:27], v[64:65] op_sel:[0,0] op_sel_hi:[1,0]
    v_pk_add_f32 v[28:29], v[28:29], v[60:61] op_sel:[0,0] op_sel_hi:[1,0] neg_lo:[0,1] neg_hi:[0,1]
    v_cvt_pk_bf16_f32 v92, v28, v29
    v_lshlrev_b32 v28, 16, v92
    v_and_b32 v29, 0xffff0000, v92
    v_pk_mul_f32 v[28:29], v[28:29], v[64:65] op_sel:[0,0] op_sel_hi:[1,0]
    v_pk_add_f32 v[30:31], v[30:31], v[60:61] op_sel:[0,0] op_sel_hi:[1,0] neg_lo:[0,1] neg_hi:[0,1]
    v_cvt_pk_bf16_f32 v92, v30, v31
    v_lshlrev_b32 v30, 16, v92
    v_and_b32 v31, 0xffff0000, v92
    v_pk_mul_f32 v[30:31], v[30:31], v[64:65] op_sel:[0,0] op_sel_hi:[1,0]
    v_pk_add_f32 v[32:33], v[32:33], v[66:67] op_sel:[0,0] op_sel_hi:[1,0] neg_lo:[0,1] neg_hi:[0,1]
    v_cvt_pk_bf16_f32 v93, v32, v33
    v_lshlrev_b32 v32, 16, v93
    v_and_b32 v33, 0xffff0000, v93
    v_pk_mul_f32 v[32:33], v[32:33], v[70:71] op_sel:[0,0] op_sel_hi:[1,0]
    v_pk_add_f32 v[34:35], v[34:35], v[66:67] op_sel:[0,0] op_sel_hi:[1,0] neg_lo:[0,1] neg_hi:[0,1]
    v_cvt_pk_bf16_f32 v93, v34, v35
    v_lshlrev_b32 v34, 16, v93
    v_and_b32 v35, 0xffff0000, v93
    v_pk_mul_f32 v[34:35], v[34:35], v[70:71] op_sel:[0,0] op_sel_hi:[1,0]
    v_pk_add_f32 v[36:37], v[36:37], v[66:67] op_sel:[0,0] op_sel_hi:[1,0] neg_lo:[0,1] neg_hi:[0,1]
    v_cvt_pk_bf16_f32 v93, v36, v37
    v_lshlrev_b32 v36, 16, v93
    v_and_b32 v37, 0xffff0000, v93
    v_pk_mul_f32 v[36:37], v[36:37], v[70:71] op_sel:[0,0] op_sel_hi:[1,0]
    v_pk_add_f32 v[38:39], v[38:39], v[66:67] op_sel:[0,0] op_sel_hi:[1,0] neg_lo:[0,1] neg_hi:[0,1]
    v_cvt_pk_bf16_f32 v93, v38, v39
    v_lshlrev_b32 v38, 16, v93
    v_and_b32 v39, 0xffff0000, v93
    v_pk_mul_f32 v[38:39], v[38:39], v[70:71] op_sel:[0,0] op_sel_hi:[1,0]
    v_pk_add_f32 v[40:41], v[40:41], v[72:73] op_sel:[0,0] op_sel_hi:[1,0] neg_lo:[0,1] neg_hi:[0,1]
    v_cvt_pk_bf16_f32 v92, v40, v41
    v_lshlrev_b32 v40, 16, v92
    v_and_b32 v41, 0xffff0000, v92
    v_pk_mul_f32 v[40:41], v[40:41], v[76:77] op_sel:[0,0] op_sel_hi:[1,0]
    v_pk_add_f32 v[42:43], v[42:43], v[72:73] op_sel:[0,0] op_sel_hi:[1,0] neg_lo:[0,1] neg_hi:[0,1]
    v_cvt_pk_bf16_f32 v92, v42, v43
    v_lshlrev_b32 v42, 16, v92
    v_and_b32 v43, 0xffff0000, v92
    v_pk_mul_f32 v[42:43], v[42:43], v[76:77] op_sel:[0,0] op_sel_hi:[1,0]
    v_pk_add_f32 v[44:45], v[44:45], v[72:73] op_sel:[0,0] op_sel_hi:[1,0] neg_lo:[0,1] neg_hi:[0,1]
    v_cvt_pk_bf16_f32 v92, v44, v45
    v_lshlrev_b32 v44, 16, v92
    v_and_b32 v45, 0xffff0000, v92
    v_pk_mul_f32 v[44:45], v[44:45], v[76:77] op_sel:[0,0] op_sel_hi:[1,0]
    v_pk_add_f32 v[46:47], v[46:47], v[72:73] op_sel:[0,0] op_sel_hi:[1,0] neg_lo:[0,1] neg_hi:[0,1]
    v_cvt_pk_bf16_f32 v92, v46, v47
    v_lshlrev_b32 v46, 16, v92
    v_and_b32 v47, 0xffff0000, v92
    v_pk_mul_f32 v[46:47], v[46:47], v[76:77] op_sel:[0,0] op_sel_hi:[1,0]
    v_pk_add_f32 v[48:49], v[48:49], v[78:79] op_sel:[0,0] op_sel_hi:[1,0] neg_lo:[0,1] neg_hi:[0,1]
    v_cvt_pk_bf16_f32 v93, v48, v49
    v_lshlrev_b32 v48, 16, v93
    v_and_b32 v49, 0xffff0000, v93
    v_pk_mul_f32 v[48:49], v[48:49], v[82:83] op_sel:[0,0] op_sel_hi:[1,0]
    v_pk_add_f32 v[50:51], v[50:51], v[78:79] op_sel:[0,0] op_sel_hi:[1,0] neg_lo:[0,1] neg_hi:[0,1]
    v_cvt_pk_bf16_f32 v93, v50, v51
    v_lshlrev_b32 v50, 16, v93
    v_and_b32 v51, 0xffff0000, v93
    v_pk_mul_f32 v[50:51], v[50:51], v[82:83] op_sel:[0,0] op_sel_hi:[1,0]
    v_pk_add_f32 v[52:53], v[52:53], v[78:79] op_sel:[0,0] op_sel_hi:[1,0] neg_lo:[0,1] neg_hi:[0,1]
    v_cvt_pk_bf16_f32 v93, v52, v53
    v_lshlrev_b32 v52, 16, v93
    v_and_b32 v53, 0xffff0000, v93
    v_pk_mul_f32 v[52:53], v[52:53], v[82:83] op_sel:[0,0] op_sel_hi:[1,0]
    v_pk_add_f32 v[54:55], v[54:55], v[78:79] op_sel:[0,0] op_sel_hi:[1,0] neg_lo:[0,1] neg_hi:[0,1]
    v_cvt_pk_bf16_f32 v93, v54, v55
    v_lshlrev_b32 v54, 16, v93
    v_and_b32 v55, 0xffff0000, v93
    v_pk_mul_f32 v[54:55], v[54:55], v[82:83] op_sel:[0,0] op_sel_hi:[1,0]
    s_mov_b32 exec_hi, 0x00ffffff
    v_cvt_pk_bf16_f32 v16, v24, v32
    v_cvt_pk_bf16_f32 v17, v40, v48
    v_xor_b32 v92, 0, v4
    ds_write_b64 v92, v[16:17]
    v_cvt_pk_bf16_f32 v18, v25, v33
    v_cvt_pk_bf16_f32 v19, v41, v49
    v_xor_b32 v93, 32, v4
    ds_write_b64 v93, v[18:19]
    v_cvt_pk_bf16_f32 v20, v26, v34
    v_cvt_pk_bf16_f32 v21, v42, v50
    v_xor_b32 v94, 64, v4
    ds_write_b64 v94, v[20:21]
    v_cvt_pk_bf16_f32 v22, v27, v35
    v_cvt_pk_bf16_f32 v23, v43, v51
    v_xor_b32 v95, 96, v4
    ds_write_b64 v95, v[22:23]
    v_cvt_pk_bf16_f32 v16, v28, v36
    v_cvt_pk_bf16_f32 v17, v44, v52
    v_xor_b32 v92, 128, v4
    ds_write_b64 v92, v[16:17]
    v_cvt_pk_bf16_f32 v18, v29, v37
    v_cvt_pk_bf16_f32 v19, v45, v53
    v_xor_b32 v93, 160, v4
    ds_write_b64 v93, v[18:19]
    v_cvt_pk_bf16_f32 v20, v30, v38
    v_cvt_pk_bf16_f32 v21, v46, v54
    v_xor_b32 v94, 192, v4
    ds_write_b64 v94, v[20:21]
    v_cvt_pk_bf16_f32 v22, v31, v39
    v_cvt_pk_bf16_f32 v23, v47, v55
    v_xor_b32 v95, 224, v4
    ds_write_b64 v95, v[22:23]
    s_mov_b32 exec_hi, -1
    v_mov_b32 v8, v60
    v_mov_b32 v9, v64
    v_mov_b32 v10, v66
    v_mov_b32 v11, v70
    v_mov_b32 v12, v72
    v_mov_b32 v13, v76
    v_mov_b32 v14, v78
    v_mov_b32 v15, v82
    v_cmp_gt_u32 vcc, 128, v0
    s_waitcnt lgkmcnt(0)
    s_barrier
    ds_read_b128 v[24:27], v6 offset:0
    ds_read_b128 v[28:31], v6 offset:4096
    ds_read_b128 v[32:35], v6 offset:8192
    ds_read_b128 v[36:39], v6 offset:12288
    s_waitcnt lgkmcnt(3)
    buffer_store_dwordx4 v[24:27], v5, s[32:35], s16 offen sc1
    s_waitcnt lgkmcnt(2)
    buffer_store_dwordx4 v[28:31], v5, s[32:35], s17 offen sc1
    s_waitcnt lgkmcnt(1)
    buffer_store_dwordx4 v[32:35], v5, s[32:35], s19 offen sc1
    s_waitcnt lgkmcnt(0)
    s_and_saveexec_b64 s[40:41], vcc
    s_cbranch_execz F1_st3
    buffer_store_dwordx4 v[36:39], v5, s[32:35], s20 offen sc1
F1_st3:
    s_mov_b64 exec, s[40:41]
    s_waitcnt vmcnt(0)
    s_barrier
    s_mov_b32 exec_lo, 1
    s_mov_b32 exec_hi, 0
    buffer_store_dwordx4 v[8:11], v7, s[32:35], s18 offen
    buffer_store_dwordx4 v[12:15], v7, s[32:35], s18 offen offset:16
    s_mov_b64 exec, -1
    v_mov_b32 v1, 0
    v_mov_b32 v2, 1
    v_mov_b32 v3, 1
    v_cmp_eq_u32 vcc, 0, v0
    s_and_saveexec_b64 s[40:41], vcc
    s_cbranch_execz F1_end
    buffer_atomic_add v2, v1, s[60:63], 0 offen sc0 sc1
    s_waitcnt vmcnt(0)
    v_readfirstlane_b32 s39, v2
    s_cmp_lg_u32 s39, 155
    s_cbranch_scc1 F1_end
    buffer_store_dword v3, v1, s[60:63], 0 offen offset:128 sc1
    s_endpgm
F1_gemv:
    s_mov_b32 s20, 0
    s_mov_b32 s21, 344064
    s_mov_b32 s22, 688128
    s_mov_b32 s23, 1032192
    s_mov_b32 s24, 1376256
    s_mov_b32 s25, 1720320
    s_mov_b32 s26, 2064384
    v_lshrrev_b32 v1, 2, v0
    v_and_b32 v2, 3, v0
    v_mul_u32_u24 v3, 5376, v1
    v_lshl_add_u32 v3, v2, 4, v3
    s_lshl_b32 s39, s42, 6
    v_add_u32 v3, s39, v3
    v_lshlrev_b32 v4, 1, v1
    s_waitcnt lgkmcnt(0)
    buffer_load_ushort v8, v4, s[56:59], 0 offen offset:0
    buffer_load_ushort v9, v4, s[56:59], 0 offen offset:128
    buffer_load_ushort v10, v4, s[56:59], 0 offen offset:256
    buffer_load_ushort v11, v4, s[56:59], 0 offen offset:384
    buffer_load_ushort v12, v4, s[56:59], 0 offen offset:512
    buffer_load_ushort v13, v4, s[56:59], 0 offen offset:640
    buffer_load_ushort v14, v4, s[56:59], 0 offen offset:768
    buffer_load_dwordx4 v[16:19], v3, s[52:55], s20 offen
    buffer_load_dwordx4 v[20:23], v3, s[52:55], s21 offen
    buffer_load_dwordx4 v[24:27], v3, s[52:55], s22 offen
    buffer_load_dwordx4 v[28:31], v3, s[52:55], s23 offen
    buffer_load_dwordx4 v[32:35], v3, s[52:55], s24 offen
    buffer_load_dwordx4 v[36:39], v3, s[52:55], s25 offen
    buffer_load_dwordx4 v[40:43], v3, s[52:55], s26 offen
    s_waitcnt vmcnt(7)
    v_lshlrev_b32 v8, 16, v8
    v_lshlrev_b32 v9, 16, v9
    v_lshlrev_b32 v10, 16, v10
    v_lshlrev_b32 v11, 16, v11
    v_lshlrev_b32 v12, 16, v12
    v_lshlrev_b32 v13, 16, v13
    v_lshlrev_b32 v14, 16, v14
    v_max_f32 v100, 0xc2ae0000, v8
    v_max_f32 v101, 0xc2ae0000, v9
    v_max_f32 v102, 0xc2ae0000, v10
    v_max_f32 v103, 0xc2ae0000, v11
    v_max_f32 v104, 0xc2ae0000, v12
    v_max_f32 v105, 0xc2ae0000, v13
    v_max_f32 v106, 0xc2ae0000, v14
    v_min_f32 v100, 0x42ae0000, v100
    v_min_f32 v101, 0x42ae0000, v101
    v_min_f32 v102, 0x42ae0000, v102
    v_min_f32 v103, 0x42ae0000, v103
    v_min_f32 v104, 0x42ae0000, v104
    v_min_f32 v105, 0x42ae0000, v105
    v_min_f32 v106, 0x42ae0000, v106
    v_mul_f32 v68, s36, v100
    v_mul_f32 v69, s36, v101
    v_mul_f32 v70, s36, v102
    v_mul_f32 v71, s36, v103
    v_mul_f32 v72, s36, v104
    v_mul_f32 v73, s36, v105
    v_mul_f32 v74, s36, v106
    v_fma_f32 v76, v100, s36, -v68
    v_fma_f32 v77, v101, s36, -v69
    v_fma_f32 v78, v102, s36, -v70
    v_fma_f32 v79, v103, s36, -v71
    v_fma_f32 v80, v104, s36, -v72
    v_fma_f32 v81, v105, s36, -v73
    v_fma_f32 v82, v106, s36, -v74
    v_fma_f32 v76, v100, s37, v76
    v_fma_f32 v77, v101, s37, v77
    v_fma_f32 v78, v102, s37, v78
    v_fma_f32 v79, v103, s37, v79
    v_fma_f32 v80, v104, s37, v80
    v_fma_f32 v81, v105, s37, v81
    v_fma_f32 v82, v106, s37, v82
    v_exp_f32_e64 v68, -v68
    v_exp_f32_e64 v69, -v69
    v_exp_f32_e64 v70, -v70
    v_exp_f32_e64 v71, -v71
    v_exp_f32_e64 v72, -v72
    v_exp_f32_e64 v73, -v73
    v_exp_f32_e64 v74, -v74
    v_mul_f32 v76, s38, v76
    v_mul_f32 v77, s38, v77
    v_mul_f32 v78, s38, v78
    v_mul_f32 v79, s38, v79
    v_mul_f32 v80, s38, v80
    v_mul_f32 v81, s38, v81
    v_mul_f32 v82, s38, v82
    v_fma_f32 v68, v68, -v76, v68
    v_fma_f32 v69, v69, -v77, v69
    v_fma_f32 v70, v70, -v78, v70
    v_fma_f32 v71, v71, -v79, v71
    v_fma_f32 v72, v72, -v80, v72
    v_fma_f32 v73, v73, -v81, v73
    v_fma_f32 v74, v74, -v82, v74
    v_add_f32 v68, 1.0, v68
    v_add_f32 v69, 1.0, v69
    v_add_f32 v70, 1.0, v70
    v_add_f32 v71, 1.0, v71
    v_add_f32 v72, 1.0, v72
    v_add_f32 v73, 1.0, v73
    v_add_f32 v74, 1.0, v74
    v_rcp_f32 v76, v68
    v_rcp_f32 v77, v69
    v_rcp_f32 v78, v70
    v_rcp_f32 v79, v71
    v_rcp_f32 v80, v72
    v_rcp_f32 v81, v73
    v_rcp_f32 v82, v74
    v_mul_f32 v84, v8, v76
    v_mul_f32 v85, v9, v77
    v_mul_f32 v86, v10, v78
    v_mul_f32 v87, v11, v79
    v_mul_f32 v88, v12, v80
    v_mul_f32 v89, v13, v81
    v_mul_f32 v90, v14, v82
    v_fma_f32 v68, -v84, v68, v8
    v_fma_f32 v69, -v85, v69, v9
    v_fma_f32 v70, -v86, v70, v10
    v_fma_f32 v71, -v87, v71, v11
    v_fma_f32 v72, -v88, v72, v12
    v_fma_f32 v73, -v89, v73, v13
    v_fma_f32 v74, -v90, v74, v14
    v_fma_f32 v84, v68, v76, v84
    v_fma_f32 v85, v69, v77, v85
    v_fma_f32 v86, v70, v78, v86
    v_fma_f32 v87, v71, v79, v87
    v_fma_f32 v88, v72, v80, v88
    v_fma_f32 v89, v73, v81, v89
    v_fma_f32 v90, v74, v82, v90
    v_cvt_pk_bf16_f32 v84, v84, v84
    v_cvt_pk_bf16_f32 v85, v85, v85
    v_cvt_pk_bf16_f32 v86, v86, v86
    v_cvt_pk_bf16_f32 v87, v87, v87
    v_cvt_pk_bf16_f32 v88, v88, v88
    v_cvt_pk_bf16_f32 v89, v89, v89
    v_cvt_pk_bf16_f32 v90, v90, v90
    v_lshlrev_b32 v68, 16, v84
    v_lshlrev_b32 v70, 16, v85
    v_lshlrev_b32 v72, 16, v86
    v_lshlrev_b32 v74, 16, v87
    v_lshlrev_b32 v76, 16, v88
    v_lshlrev_b32 v78, 16, v89
    v_lshlrev_b32 v80, 16, v90
    v_mov_b32 v48, 0
    v_mov_b32 v49, 0
    v_mov_b32 v50, 0
    v_mov_b32 v51, 0
    v_mov_b32 v52, 0
    v_mov_b32 v53, 0
    v_mov_b32 v54, 0
    v_mov_b32 v55, 0
    s_waitcnt vmcnt(6)
    v_lshlrev_b32 v56, 16, v16
    v_and_b32 v57, 0xffff0000, v16
    v_pk_fma_f32 v[48:49], v[56:57], v[68:69], v[48:49] op_sel:[0,0,0] op_sel_hi:[1,0,1]
    v_lshlrev_b32 v58, 16, v17
    v_and_b32 v59, 0xffff0000, v17
    v_pk_fma_f32 v[50:51], v[58:59], v[68:69], v[50:51] op_sel:[0,0,0] op_sel_hi:[1,0,1]
    v_lshlrev_b32 v56, 16, v18
    v_and_b32 v57, 0xffff0000, v18
    v_pk_fma_f32 v[52:53], v[56:57], v[68:69], v[52:53] op_sel:[0,0,0] op_sel_hi:[1,0,1]
    v_lshlrev_b32 v58, 16, v19
    v_and_b32 v59, 0xffff0000, v19
    v_pk_fma_f32 v[54:55], v[58:59], v[68:69], v[54:55] op_sel:[0,0,0] op_sel_hi:[1,0,1]
    s_waitcnt vmcnt(5)
    v_lshlrev_b32 v56, 16, v20
    v_and_b32 v57, 0xffff0000, v20
    v_pk_fma_f32 v[48:49], v[56:57], v[70:71], v[48:49] op_sel:[0,0,0] op_sel_hi:[1,0,1]
    v_lshlrev_b32 v58, 16, v21
    v_and_b32 v59, 0xffff0000, v21
    v_pk_fma_f32 v[50:51], v[58:59], v[70:71], v[50:51] op_sel:[0,0,0] op_sel_hi:[1,0,1]
    v_lshlrev_b32 v56, 16, v22
    v_and_b32 v57, 0xffff0000, v22
    v_pk_fma_f32 v[52:53], v[56:57], v[70:71], v[52:53] op_sel:[0,0,0] op_sel_hi:[1,0,1]
    v_lshlrev_b32 v58, 16, v23
    v_and_b32 v59, 0xffff0000, v23
    v_pk_fma_f32 v[54:55], v[58:59], v[70:71], v[54:55] op_sel:[0,0,0] op_sel_hi:[1,0,1]
    s_waitcnt vmcnt(4)
    v_lshlrev_b32 v56, 16, v24
    v_and_b32 v57, 0xffff0000, v24
    v_pk_fma_f32 v[48:49], v[56:57], v[72:73], v[48:49] op_sel:[0,0,0] op_sel_hi:[1,0,1]
    v_lshlrev_b32 v58, 16, v25
    v_and_b32 v59, 0xffff0000, v25
    v_pk_fma_f32 v[50:51], v[58:59], v[72:73], v[50:51] op_sel:[0,0,0] op_sel_hi:[1,0,1]
    v_lshlrev_b32 v56, 16, v26
    v_and_b32 v57, 0xffff0000, v26
    v_pk_fma_f32 v[52:53], v[56:57], v[72:73], v[52:53] op_sel:[0,0,0] op_sel_hi:[1,0,1]
    v_lshlrev_b32 v58, 16, v27
    v_and_b32 v59, 0xffff0000, v27
    v_pk_fma_f32 v[54:55], v[58:59], v[72:73], v[54:55] op_sel:[0,0,0] op_sel_hi:[1,0,1]
    s_waitcnt vmcnt(3)
    v_lshlrev_b32 v56, 16, v28
    v_and_b32 v57, 0xffff0000, v28
    v_pk_fma_f32 v[48:49], v[56:57], v[74:75], v[48:49] op_sel:[0,0,0] op_sel_hi:[1,0,1]
    v_lshlrev_b32 v58, 16, v29
    v_and_b32 v59, 0xffff0000, v29
    v_pk_fma_f32 v[50:51], v[58:59], v[74:75], v[50:51] op_sel:[0,0,0] op_sel_hi:[1,0,1]
    v_lshlrev_b32 v56, 16, v30
    v_and_b32 v57, 0xffff0000, v30
    v_pk_fma_f32 v[52:53], v[56:57], v[74:75], v[52:53] op_sel:[0,0,0] op_sel_hi:[1,0,1]
    v_lshlrev_b32 v58, 16, v31
    v_and_b32 v59, 0xffff0000, v31
    v_pk_fma_f32 v[54:55], v[58:59], v[74:75], v[54:55] op_sel:[0,0,0] op_sel_hi:[1,0,1]
    s_waitcnt vmcnt(2)
    v_lshlrev_b32 v56, 16, v32
    v_and_b32 v57, 0xffff0000, v32
    v_pk_fma_f32 v[48:49], v[56:57], v[76:77], v[48:49] op_sel:[0,0,0] op_sel_hi:[1,0,1]
    v_lshlrev_b32 v58, 16, v33
    v_and_b32 v59, 0xffff0000, v33
    v_pk_fma_f32 v[50:51], v[58:59], v[76:77], v[50:51] op_sel:[0,0,0] op_sel_hi:[1,0,1]
    v_lshlrev_b32 v56, 16, v34
    v_and_b32 v57, 0xffff0000, v34
    v_pk_fma_f32 v[52:53], v[56:57], v[76:77], v[52:53] op_sel:[0,0,0] op_sel_hi:[1,0,1]
    v_lshlrev_b32 v58, 16, v35
    v_and_b32 v59, 0xffff0000, v35
    v_pk_fma_f32 v[54:55], v[58:59], v[76:77], v[54:55] op_sel:[0,0,0] op_sel_hi:[1,0,1]
    s_waitcnt vmcnt(1)
    v_lshlrev_b32 v56, 16, v36
    v_and_b32 v57, 0xffff0000, v36
    v_pk_fma_f32 v[48:49], v[56:57], v[78:79], v[48:49] op_sel:[0,0,0] op_sel_hi:[1,0,1]
    v_lshlrev_b32 v58, 16, v37
    v_and_b32 v59, 0xffff0000, v37
    v_pk_fma_f32 v[50:51], v[58:59], v[78:79], v[50:51] op_sel:[0,0,0] op_sel_hi:[1,0,1]
    v_lshlrev_b32 v56, 16, v38
    v_and_b32 v57, 0xffff0000, v38
    v_pk_fma_f32 v[52:53], v[56:57], v[78:79], v[52:53] op_sel:[0,0,0] op_sel_hi:[1,0,1]
    v_lshlrev_b32 v58, 16, v39
    v_and_b32 v59, 0xffff0000, v39
    v_pk_fma_f32 v[54:55], v[58:59], v[78:79], v[54:55] op_sel:[0,0,0] op_sel_hi:[1,0,1]
    s_waitcnt vmcnt(0)
    v_lshlrev_b32 v56, 16, v40
    v_and_b32 v57, 0xffff0000, v40
    v_pk_fma_f32 v[48:49], v[56:57], v[80:81], v[48:49] op_sel:[0,0,0] op_sel_hi:[1,0,1]
    v_lshlrev_b32 v58, 16, v41
    v_and_b32 v59, 0xffff0000, v41
    v_pk_fma_f32 v[50:51], v[58:59], v[80:81], v[50:51] op_sel:[0,0,0] op_sel_hi:[1,0,1]
    v_lshlrev_b32 v56, 16, v42
    v_and_b32 v57, 0xffff0000, v42
    v_pk_fma_f32 v[52:53], v[56:57], v[80:81], v[52:53] op_sel:[0,0,0] op_sel_hi:[1,0,1]
    v_lshlrev_b32 v58, 16, v43
    v_and_b32 v59, 0xffff0000, v43
    v_pk_fma_f32 v[54:55], v[58:59], v[80:81], v[54:55] op_sel:[0,0,0] op_sel_hi:[1,0,1]
    v_add_f32_dpp v48, v48, v48 row_ror:4 row_mask:0xf bank_mask:0xf
    v_add_f32_dpp v49, v49, v49 row_ror:4 row_mask:0xf bank_mask:0xf
    v_add_f32_dpp v50, v50, v50 row_ror:4 row_mask:0xf bank_mask:0xf
    v_add_f32_dpp v51, v51, v51 row_ror:4 row_mask:0xf bank_mask:0xf
    v_add_f32_dpp v52, v52, v52 row_ror:4 row_mask:0xf bank_mask:0xf
    v_add_f32_dpp v53, v53, v53 row_ror:4 row_mask:0xf bank_mask:0xf
    v_add_f32_dpp v54, v54, v54 row_ror:4 row_mask:0xf bank_mask:0xf
    v_add_f32_dpp v55, v55, v55 row_ror:4 row_mask:0xf bank_mask:0xf
    v_add_f32_dpp v48, v48, v48 row_ror:8 row_mask:0xf bank_mask:0xf
    v_add_f32_dpp v49, v49, v49 row_ror:8 row_mask:0xf bank_mask:0xf
    v_add_f32_dpp v50, v50, v50 row_ror:8 row_mask:0xf bank_mask:0xf
    v_add_f32_dpp v51, v51, v51 row_ror:8 row_mask:0xf bank_mask:0xf
    v_add_f32_dpp v52, v52, v52 row_ror:8 row_mask:0xf bank_mask:0xf
    v_add_f32_dpp v53, v53, v53 row_ror:8 row_mask:0xf bank_mask:0xf
    v_add_f32_dpp v54, v54, v54 row_ror:8 row_mask:0xf bank_mask:0xf
    v_add_f32_dpp v55, v55, v55 row_ror:8 row_mask:0xf bank_mask:0xf
    v_lshrrev_b32 v5, 4, v0
    v_lshlrev_b32 v5, 7, v5
    v_lshl_add_u32 v5, v2, 5, v5
    v_and_b32 v6, 12, v0
    v_cmp_eq_u32 vcc, 0, v6
    s_and_saveexec_b64 s[40:41], vcc
    ds_write_b128 v5, v[48:51] offset:16384
    ds_write_b128 v5, v[52:55] offset:16400
    s_mov_b64 exec, s[40:41]
    s_waitcnt lgkmcnt(0)
    s_barrier
    v_lshlrev_b32 v5, 2, v0
    v_cmp_gt_u32 vcc, 32, v0
    s_and_saveexec_b64 s[40:41], vcc
    s_cbranch_execz F1_end
    ds_read_b32 v16, v5 offset:16384
    ds_read_b32 v17, v5 offset:16512
    ds_read_b32 v18, v5 offset:16640
    ds_read_b32 v19, v5 offset:16768
    ds_read_b32 v20, v5 offset:16896
    ds_read_b32 v21, v5 offset:17024
    ds_read_b32 v22, v5 offset:17152
    ds_read_b32 v23, v5 offset:17280
    ds_read_b32 v24, v5 offset:17408
    ds_read_b32 v25, v5 offset:17536
    ds_read_b32 v26, v5 offset:17664
    ds_read_b32 v27, v5 offset:17792
    ds_read_b32 v28, v5 offset:17920
    ds_read_b32 v29, v5 offset:18048
    ds_read_b32 v30, v5 offset:18176
    ds_read_b32 v31, v5 offset:18304
    s_waitcnt lgkmcnt(0)
    v_add_f32 v16, v16, v24
    v_add_f32 v17, v17, v25
    v_add_f32 v18, v18, v26
    v_add_f32 v19, v19, v27
    v_add_f32 v20, v20, v28
    v_add_f32 v21, v21, v29
    v_add_f32 v22, v22, v30
    v_add_f32 v23, v23, v31
    v_add_f32 v16, v16, v20
    v_add_f32 v17, v17, v21
    v_add_f32 v18, v18, v22
    v_add_f32 v19, v19, v23
    v_add_f32 v16, v16, v18
    v_add_f32 v17, v17, v19
    v_add_f32 v16, v16, v17
    v_cvt_pk_bf16_f32 v17, v16, v16
    v_lshlrev_b32 v16, 16, v17
    s_lshl_b32 s39, s42, 7
    v_add_u32 v5, s39, v5
    buffer_store_dword v16, v5, s[32:35], 0 offen offset:0 sc1
    s_sub_u32 s39, s42, 14
    s_cmp_lt_u32 s39, 14
    s_cselect_b32 s28, 1.0, 0
    s_sub_u32 s39, s42, 56
    s_cmp_lt_u32 s39, 14
    s_cselect_b32 s28, 1.0, s28
    v_add_f32 v18, s28, v16
    v_cvt_pk_bf16_f32 v18, v18, v18
    v_lshrrev_b32 v6, 1, v5
    s_mov_b32 s39, 16384
    s_waitcnt vmcnt(0)
    buffer_store_short v18, v6, s[32:35], s39 offen
    s_cmp_ge_u32 s42, 28
    s_cbranch_scc1 F1_end
    v_mov_b32 v1, 0
    v_mov_b32 v2, 1
    v_mov_b32 v3, 1
    v_cmp_eq_u32 vcc, 0, v0
    s_and_saveexec_b64 s[40:41], vcc
    s_cbranch_execz F1_end
    buffer_atomic_add v2, v1, s[60:63], 0 offen sc0 sc1
    s_waitcnt vmcnt(0)
    v_readfirstlane_b32 s39, v2
    s_cmp_lg_u32 s39, 155
    s_cbranch_scc1 F1_end
    buffer_store_dword v3, v1, s[60:63], 0 offen offset:128 sc1
    s_endpgm
F1_cpf:
    s_getpc_b64 s[44:45]
F1_pcref:
    v_lshlrev_b32 v4, 6, v0
    v_add_u32 v6, 16384, v4
    v_min_u32 v4, CODE_END-F1_pcref-4, v4
    v_min_u32 v6, CODE_END-F1_pcref-4, v6
    v_mov_b32 v15, s45
    v_add_co_u32 v14, vcc, s44, v4
    s_nop 1
    v_addc_co_u32 v15, vcc, 0, v15, vcc
    v_mov_b32 v17, s45
    v_add_co_u32 v16, vcc, s44, v6
    s_nop 1
    v_addc_co_u32 v17, vcc, 0, v17, vcc
    global_load_dword v3, v[14:15], off
    global_load_dword v5, v[16:17], off
    s_endpgm
F1_conv:
    s_sub_u32 s38, s2, 156
    s_setprio 1
    s_cmp_lt_u32 s38, 256
    s_cbranch_scc1 F1_p1
    s_setprio 2
F1_p1:
    s_and_b32 s3, s38, 7
    s_mul_i32 s3, s3, 56
    s_lshr_b32 s39, s38, 3
    s_add_u32 s3, s3, s39
    s_mov_b32 s40, 0x3fb8aa3b
    s_mov_b32 s41, 0x32a57060
    s_mov_b32 s42, 0x3f317218
    s_mov_b32 s43, 0x3e22f983
    s_mov_b32 s44, 0x31dc9c88
    s_lshl_b32 s36, s3, 9
    s_lshl_b32 s37, s3, 1
    v_lshlrev_b32 v1, 1, v0
    v_mov_b32 v2, s37
    s_mov_b32 s30, 896
    s_mov_b32 s31, 0x20000
    s_mov_b32 s34, 268435456
    s_mov_b32 s35, 0x20000
    s_mov_b32 s62, 256
    s_mov_b32 s63, 0x20000
    s_mov_b32 s50, 229376
    s_mov_b32 s51, 0x20000
    s_mov_b32 s54, 229376
    s_mov_b32 s55, 0x20000
    s_mov_b32 s58, 229376
    s_mov_b32 s59, 0x20000
    s_waitcnt lgkmcnt(0)
    s_mov_b64 s[28:29], s[18:19]
    s_mov_b64 s[32:33], s[26:27]
    s_mov_b64 s[60:61], s[24:25]
    buffer_load_ushort v3, v2, s[28:31], 0 offen
    s_mov_b64 s[48:49], s[6:7]
    buffer_load_ushort v4, v1, s[48:51], s36 offen
    s_mov_b64 s[52:53], s[8:9]
    buffer_load_ushort v5, v1, s[52:55], s36 offen
    s_mov_b64 s[56:57], s[10:11]
    buffer_load_ushort v6, v1, s[56:59], s36 offen
    s_mov_b64 s[48:49], s[12:13]
    buffer_load_ushort v7, v1, s[48:51], s36 offen
    s_mov_b64 s[52:53], s[14:15]
    buffer_load_ushort v8, v1, s[52:55], s36 offen
    s_mov_b64 s[56:57], s[16:17]
    buffer_load_ushort v9, v1, s[56:59], s36 offen
    v_and_b32 v10, 63, v0
    v_and_b32 v11, 15, v0
    v_bfe_u32 v12, v0, 4, 2
    v_lshrrev_b32 v13, 6, v0
    v_mov_b32 v14, v11
    v_lshlrev_b32 v15, 1, v11
    v_add_u32 v15, 240, v15
    v_cmp_le_u32_e64 s[46:47], 8, v11
    v_cmp_le_u32_e64 s[48:49], 12, v11
    v_cmp_le_u32_e64 s[50:51], 14, v11
    v_lshlrev_b32 v20, 2, v11
    v_add_u32 v21, 464, v20
    v_add_u32 v20, 712, v20
    v_cndmask_b32_e64 v14, v14, v15, s[46:47]
    v_cndmask_b32_e64 v14, v14, v21, s[48:49]
    v_cndmask_b32_e64 v14, v14, v20, s[50:51]
    v_cvt_f32_u32 v16, v14
    v_sub_f32 v17, 0, v16
    v_lshlrev_b32 v15, 3, v11
    v_cvt_f32_u32 v18, v15
    v_mov_b32 v19, v18
    v_mul_u32_u24 v2, 2656, v13
    v_cmp_le_u32_e64 s[46:47], 2, v12
    v_cmp_eq_u32_e64 s[48:49], 3, v12
    v_add_u32 v20, -1, v12
    v_max_i32 v20, 0, v20
    v_sub_u32 v21, 3, v20
    v_lshlrev_b32 v22, v21, v11
    v_lshlrev_b32 v23, 2, v12
    v_lshlrev_b32 v24, 7, v12
    v_cndmask_b32_e64 v23, v23, v24, s[46:47]
    v_add_u32 v22, v22, v23
    v_lshl_add_u32 v154, v22, 2, v2
    v_add_u32 v24, 248, v154
    v_cndmask_b32_e64 v155, v154, v24, s[48:49]
    v_mov_b32 v25, 64
    v_lshlrev_b32 v24, v21, v25
    v_add_u32 v156, v154, v24
    v_add_u32 v157, v155, v24
    v_lshl_add_u32 v22, v12, 6, v11
    v_lshl_add_u32 v158, v22, 2, v2
    v_lshlrev_b32 v159, 6, v13
    v_lshl_add_u32 v159, v12, 2, v159
    v_min_u32 v24, 9, v11
    v_lshlrev_b32 v15, 10, v24
    v_lshl_add_u32 v15, v159, 2, v15
    v_add_u32 v15, 8192, v15
    v_lshlrev_b32 v159, 5, v159
    v_mov_b32 v112, 0
    v_mov_b32 v113, 0
    v_mov_b32 v114, 0
    v_mov_b32 v115, 0
    v_mov_b32 v116, 0
    v_mov_b32 v117, 0
    v_mov_b32 v118, 0
    v_mov_b32 v119, 0
    v_mov_b32 v120, 0
    v_mov_b32 v121, 0
    v_mov_b32 v122, 0
    v_mov_b32 v123, 0
    v_mov_b32 v124, 0
    v_mov_b32 v125, 0
    v_mov_b32 v126, 0
    v_mov_b32 v127, 0
    s_waitcnt vmcnt(6)
    v_lshlrev_b32 v3, 16, v3
    v_mul_f32 v41, s40, v3
    v_fma_f32 v42, v3, s40, -v41
    v_fma_f32 v42, v3, s41, v42
    v_exp_f32 v40, v41
    v_mul_f32 v42, s42, v42
    v_fma_f32 v40, v40, v42, v40
    v_cvt_pk_bf16_f32 v41, v40, v40
    v_lshlrev_b32 v40, 16, v41
    s_waitcnt vmcnt(0)
    v_lshlrev_b32 v4, 16, v4
    v_lshlrev_b32 v5, 16, v5
    v_lshlrev_b32 v6, 16, v6
    v_lshlrev_b32 v7, 16, v7
    v_lshlrev_b32 v8, 16, v8
    v_lshlrev_b32 v9, 16, v9
    v_mul_f32 v4, v40, v4
    v_mul_f32 v5, v40, v5
    v_mul_f32 v6, v40, v6
    v_mul_f32 v7, v40, v7
    v_mul_f32 v24, s40, v4
    v_mul_f32 v25, s43, v5
    v_and_b32 v25, 0xffffff00, v25
    v_fma_f32 v26, v5, s43, -v25
    v_fma_f32 v26, v5, s44, v26
    v_pk_mul_f32 v[36:37], v[8:9], v[6:7] op_sel:[0,0] op_sel_hi:[1,0]
    v_pk_fma_f32 v[28:29], v[8:9], v[6:7], v[36:37] op_sel:[1,1,0] op_sel_hi:[0,1,1] neg_lo:[1,0,0]
    v_sub_f32 v29, 0, v29
    v_mov_b32 v48, 0x43000000
    v_mov_b32 v49, 0x43000000
    v_mov_b32 v56, 0x44800000
    v_mov_b32 v57, 0xc4800000
    v_mov_b32 v64, 0x43800000
    v_mov_b32 v65, 0xc3800000
    v_pk_mul_f32 v[52:53], v[24:25], v[48:49]
    v_pk_mul_f32 v[60:61], v[24:25], v[56:57]
    v_pk_mul_f32 v[68:69], v[24:25], v[64:65]
    v_exp_f32 v50, v52
    v_exp_f32 v58, v60
    v_exp_f32 v66, v68
    v_fract_f32 v53, v53
    v_fract_f32 v61, v61
    v_fract_f32 v69, v69
    v_fma_f32 v53, v26, v49, v53
    v_fma_f32 v61, v26, v57, v61
    v_fma_f32 v69, v26, v65, v69
    v_cos_f32 v52, v53
    v_sin_f32 v53, v53
    v_cos_f32 v60, v61
    v_sin_f32 v61, v61
    v_cos_f32 v68, v69
    v_sin_f32 v69, v69
    v_pk_mul_f32 v[30:31], v[52:53], v[50:51] op_sel:[0,0] op_sel_hi:[1,0]
    v_pk_mul_f32 v[32:33], v[60:61], v[58:59] op_sel:[0,0] op_sel_hi:[1,0]
    v_pk_mul_f32 v[34:35], v[68:69], v[66:67] op_sel:[0,0] op_sel_hi:[1,0]
    v_lshlrev_b32 v1, 5, v0
    ds_write_b128 v1, v[24:27] offset:0
    ds_write_b128 v1, v[28:31] offset:16
    v_pk_mul_f32 v[36:37], v[32:33], v[28:29] op_sel:[0,0] op_sel_hi:[1,0]
    v_pk_fma_f32 v[72:73], v[32:33], v[28:29], v[36:37] op_sel:[1,1,0] op_sel_hi:[0,1,1] neg_lo:[1,0,0]
    v_pk_mul_f32 v[36:37], v[72:73], v[34:35] op_sel:[0,0] op_sel_hi:[1,0]
    v_pk_fma_f32 v[74:75], v[72:73], v[34:35], v[36:37] op_sel:[1,1,0] op_sel_hi:[0,1,1] neg_lo:[1,0,0]
    v_pk_mul_f32 v[36:37], v[74:75], v[34:35] op_sel:[0,0] op_sel_hi:[1,0]
    v_pk_fma_f32 v[76:77], v[74:75], v[34:35], v[36:37] op_sel:[1,1,0] op_sel_hi:[0,1,1] neg_lo:[1,0,0]
    v_pk_mul_f32 v[36:37], v[76:77], v[34:35] op_sel:[0,0] op_sel_hi:[1,0]
    v_pk_fma_f32 v[78:79], v[76:77], v[34:35], v[36:37] op_sel:[1,1,0] op_sel_hi:[0,1,1] neg_lo:[1,0,0]
    v_pk_mul_f32 v[36:37], v[78:79], v[34:35] op_sel:[0,0] op_sel_hi:[1,0]
    v_pk_fma_f32 v[80:81], v[78:79], v[34:35], v[36:37] op_sel:[1,1,0] op_sel_hi:[0,1,1] neg_lo:[1,0,0]
    v_lshlrev_b32 v1, 2, v0
    v_cvt_pk_bf16_f32 v84, v72, v73
    v_lshlrev_b32 v48, 16, v84
    v_and_b32 v49, 0xffff0000, v84
    v_pk_add_f32 v[48:49], v[72:73], v[48:49] neg_lo:[0,1] neg_hi:[0,1]
    v_cvt_pk_bf16_f32 v85, v48, v49
    ds_write_b32 v1, v84 offset:8192
    ds_write_b32 v1, v85 offset:9216
    v_cvt_pk_bf16_f32 v86, v74, v75
    v_lshlrev_b32 v50, 16, v86
    v_and_b32 v51, 0xffff0000, v86
    v_pk_add_f32 v[50:51], v[74:75], v[50:51] neg_lo:[0,1] neg_hi:[0,1]
    v_cvt_pk_bf16_f32 v87, v50, v51
    ds_write_b32 v1, v86 offset:10240
    ds_write_b32 v1, v87 offset:11264
    v_cvt_pk_bf16_f32 v88, v76, v77
    v_lshlrev_b32 v52, 16, v88
    v_and_b32 v53, 0xffff0000, v88
    v_pk_add_f32 v[52:53], v[76:77], v[52:53] neg_lo:[0,1] neg_hi:[0,1]
    v_cvt_pk_bf16_f32 v89, v52, v53
    ds_write_b32 v1, v88 offset:12288
    ds_write_b32 v1, v89 offset:13312
    v_cvt_pk_bf16_f32 v90, v78, v79
    v_lshlrev_b32 v54, 16, v90
    v_and_b32 v55, 0xffff0000, v90
    v_pk_add_f32 v[54:55], v[78:79], v[54:55] neg_lo:[0,1] neg_hi:[0,1]
    v_cvt_pk_bf16_f32 v91, v54, v55
    ds_write_b32 v1, v90 offset:14336
    ds_write_b32 v1, v91 offset:15360
    v_cvt_pk_bf16_f32 v92, v80, v81
    v_lshlrev_b32 v56, 16, v92
    v_and_b32 v57, 0xffff0000, v92
    v_pk_add_f32 v[56:57], v[80:81], v[56:57] neg_lo:[0,1] neg_hi:[0,1]
    v_cvt_pk_bf16_f32 v93, v56, v57
    ds_write_b32 v1, v92 offset:16384
    ds_write_b32 v1, v93 offset:17408
    v_mov_b32 v1, v159
    v_mov_b32 v3, 128
    s_waitcnt lgkmcnt(0)
    ds_read_b128 v[24:27], v1 offset:0
    ds_read_b128 v[28:31], v1 offset:16
    ds_read_b128 v[72:75], v15 offset:0
    ds_read_b128 v[32:35], v1 offset:32
    ds_read_b128 v[36:39], v1 offset:48
    s_waitcnt lgkmcnt(3)
    v_pk_mul_f32 v[128:129], v[24:25], v[16:17]
    v_pk_mul_f32 v[136:137], v[24:25], v[18:19]
    v_exp_f32 v130, v128
    v_exp_f32 v138, v136
    v_fract_f32 v129, v129
    v_fract_f32 v137, v137
    v_fma_f32 v129, v26, v17, v129
    v_fma_f32 v137, v26, v19, v137
    v_cos_f32 v132, v129
    v_sin_f32 v133, v129
    v_cos_f32 v140, v137
    v_sin_f32 v141, v137
    v_pk_mul_f32 v[132:133], v[132:133], v[130:131] op_sel:[0,0] op_sel_hi:[1,0]
    v_pk_mul_f32 v[140:141], v[140:141], v[138:139] op_sel:[0,0] op_sel_hi:[1,0]
    v_pk_mul_f32 v[128:129], v[132:133], v[28:29] op_sel:[0,0] op_sel_hi:[1,0]
    v_pk_mul_f32 v[136:137], v[140:141], v[30:31] op_sel:[0,0] op_sel_hi:[1,0]
    v_pk_fma_f32 v[134:135], v[132:133], v[28:29], v[128:129] op_sel:[1,1,0] op_sel_hi:[0,1,1] neg_lo:[1,0,0]
    v_pk_fma_f32 v[142:143], v[140:141], v[30:31], v[136:137] op_sel:[1,1,0] op_sel_hi:[0,1,1] neg_lo:[1,0,0]
    v_cvt_pk_bf16_f32 v56, v140, v141
    v_cvt_pk_bf16_f32 v48, v134, v135
    v_cvt_pk_bf16_f32 v64, v142, v143
    v_lshlrev_b32 v144, 16, v56
    v_and_b32 v145, 0xffff0000, v56
    v_lshlrev_b32 v146, 16, v48
    v_and_b32 v147, 0xffff0000, v48
    v_lshlrev_b32 v148, 16, v64
    v_and_b32 v149, 0xffff0000, v64
    v_pk_add_f32 v[144:145], v[140:141], v[144:145] neg_lo:[0,1] neg_hi:[0,1]
    v_pk_add_f32 v[146:147], v[134:135], v[146:147] neg_lo:[0,1] neg_hi:[0,1]
    v_pk_add_f32 v[148:149], v[142:143], v[148:149] neg_lo:[0,1] neg_hi:[0,1]
    v_cvt_pk_bf16_f32 v60, v144, v145
    v_cvt_pk_bf16_f32 v52, v146, v147
    v_cvt_pk_bf16_f32 v68, v148, v149
    ds_read_b128 v[24:27], v1 offset:64
    ds_read_b128 v[28:31], v1 offset:80
    s_waitcnt lgkmcnt(2)
    v_pk_mul_f32 v[128:129], v[32:33], v[16:17]
    v_pk_mul_f32 v[136:137], v[32:33], v[18:19]
    v_exp_f32 v130, v128
    v_exp_f32 v138, v136
    v_fract_f32 v129, v129
    v_fract_f32 v137, v137
    v_fma_f32 v129, v34, v17, v129
    v_fma_f32 v137, v34, v19, v137
    v_cos_f32 v132, v129
    v_sin_f32 v133, v129
    v_cos_f32 v140, v137
    v_sin_f32 v141, v137
    v_pk_mul_f32 v[132:133], v[132:133], v[130:131] op_sel:[0,0] op_sel_hi:[1,0]
    v_pk_mul_f32 v[140:141], v[140:141], v[138:139] op_sel:[0,0] op_sel_hi:[1,0]
    v_pk_mul_f32 v[128:129], v[132:133], v[36:37] op_sel:[0,0] op_sel_hi:[1,0]
    v_pk_mul_f32 v[136:137], v[140:141], v[38:39] op_sel:[0,0] op_sel_hi:[1,0]
    v_pk_fma_f32 v[134:135], v[132:133], v[36:37], v[128:129] op_sel:[1,1,0] op_sel_hi:[0,1,1] neg_lo:[1,0,0]
    v_pk_fma_f32 v[142:143], v[140:141], v[38:39], v[136:137] op_sel:[1,1,0] op_sel_hi:[0,1,1] neg_lo:[1,0,0]
    v_cvt_pk_bf16_f32 v57, v140, v141
    v_cvt_pk_bf16_f32 v49, v134, v135
    v_cvt_pk_bf16_f32 v65, v142, v143
    v_lshlrev_b32 v144, 16, v57
    v_and_b32 v145, 0xffff0000, v57
    v_lshlrev_b32 v146, 16, v49
    v_and_b32 v147, 0xffff0000, v49
    v_lshlrev_b32 v148, 16, v65
    v_and_b32 v149, 0xffff0000, v65
    v_pk_add_f32 v[144:145], v[140:141], v[144:145] neg_lo:[0,1] neg_hi:[0,1]
    v_pk_add_f32 v[146:147], v[134:135], v[146:147] neg_lo:[0,1] neg_hi:[0,1]
    v_pk_add_f32 v[148:149], v[142:143], v[148:149] neg_lo:[0,1] neg_hi:[0,1]
    v_cvt_pk_bf16_f32 v61, v144, v145
    v_cvt_pk_bf16_f32 v53, v146, v147
    v_cvt_pk_bf16_f32 v69, v148, v149
    ds_read_b128 v[32:35], v1 offset:96
    ds_read_b128 v[36:39], v1 offset:112
    s_waitcnt lgkmcnt(2)
    v_pk_mul_f32 v[128:129], v[24:25], v[16:17]
    v_pk_mul_f32 v[136:137], v[24:25], v[18:19]
    v_exp_f32 v130, v128
    v_exp_f32 v138, v136
    v_fract_f32 v129, v129
    v_fract_f32 v137, v137
    v_fma_f32 v129, v26, v17, v129
    v_fma_f32 v137, v26, v19, v137
    v_cos_f32 v132, v129
    v_sin_f32 v133, v129
    v_cos_f32 v140, v137
    v_sin_f32 v141, v137
    v_pk_mul_f32 v[132:133], v[132:133], v[130:131] op_sel:[0,0] op_sel_hi:[1,0]
    v_pk_mul_f32 v[140:141], v[140:141], v[138:139] op_sel:[0,0] op_sel_hi:[1,0]
    v_pk_mul_f32 v[128:129], v[132:133], v[28:29] op_sel:[0,0] op_sel_hi:[1,0]
    v_pk_mul_f32 v[136:137], v[140:141], v[30:31] op_sel:[0,0] op_sel_hi:[1,0]
    v_pk_fma_f32 v[134:135], v[132:133], v[28:29], v[128:129] op_sel:[1,1,0] op_sel_hi:[0,1,1] neg_lo:[1,0,0]
    v_pk_fma_f32 v[142:143], v[140:141], v[30:31], v[136:137] op_sel:[1,1,0] op_sel_hi:[0,1,1] neg_lo:[1,0,0]
    v_cvt_pk_bf16_f32 v58, v140, v141
    v_cvt_pk_bf16_f32 v50, v134, v135
    v_cvt_pk_bf16_f32 v66, v142, v143
    v_lshlrev_b32 v144, 16, v58
    v_and_b32 v145, 0xffff0000, v58
    v_lshlrev_b32 v146, 16, v50
    v_and_b32 v147, 0xffff0000, v50
    v_lshlrev_b32 v148, 16, v66
    v_and_b32 v149, 0xffff0000, v66
    v_pk_add_f32 v[144:145], v[140:141], v[144:145] neg_lo:[0,1] neg_hi:[0,1]
    v_pk_add_f32 v[146:147], v[134:135], v[146:147] neg_lo:[0,1] neg_hi:[0,1]
    v_pk_add_f32 v[148:149], v[142:143], v[148:149] neg_lo:[0,1] neg_hi:[0,1]
    v_cvt_pk_bf16_f32 v62, v144, v145
    v_cvt_pk_bf16_f32 v54, v146, v147
    v_cvt_pk_bf16_f32 v70, v148, v149
    ds_read_b128 v[24:27], v1 offset:512
    ds_read_b128 v[28:31], v1 offset:528
    s_waitcnt lgkmcnt(2)
    v_pk_mul_f32 v[128:129], v[32:33], v[16:17]
    v_pk_mul_f32 v[136:137], v[32:33], v[18:19]
    v_exp_f32 v130, v128
    v_exp_f32 v138, v136
    v_fract_f32 v129, v129
    v_fract_f32 v137, v137
    v_fma_f32 v129, v34, v17, v129
    v_fma_f32 v137, v34, v19, v137
    v_cos_f32 v132, v129
    v_sin_f32 v133, v129
    v_cos_f32 v140, v137
    v_sin_f32 v141, v137
    v_pk_mul_f32 v[132:133], v[132:133], v[130:131] op_sel:[0,0] op_sel_hi:[1,0]
    v_pk_mul_f32 v[140:141], v[140:141], v[138:139] op_sel:[0,0] op_sel_hi:[1,0]
    v_pk_mul_f32 v[128:129], v[132:133], v[36:37] op_sel:[0,0] op_sel_hi:[1,0]
    v_pk_mul_f32 v[136:137], v[140:141], v[38:39] op_sel:[0,0] op_sel_hi:[1,0]
    v_pk_fma_f32 v[134:135], v[132:133], v[36:37], v[128:129] op_sel:[1,1,0] op_sel_hi:[0,1,1] neg_lo:[1,0,0]
    v_pk_fma_f32 v[142:143], v[140:141], v[38:39], v[136:137] op_sel:[1,1,0] op_sel_hi:[0,1,1] neg_lo:[1,0,0]
    v_cvt_pk_bf16_f32 v59, v140, v141
    v_cvt_pk_bf16_f32 v51, v134, v135
    v_cvt_pk_bf16_f32 v67, v142, v143
    v_lshlrev_b32 v144, 16, v59
    v_and_b32 v145, 0xffff0000, v59
    v_lshlrev_b32 v146, 16, v51
    v_and_b32 v147, 0xffff0000, v51
    v_lshlrev_b32 v148, 16, v67
    v_and_b32 v149, 0xffff0000, v67
    v_pk_add_f32 v[144:145], v[140:141], v[144:145] neg_lo:[0,1] neg_hi:[0,1]
    v_pk_add_f32 v[146:147], v[134:135], v[146:147] neg_lo:[0,1] neg_hi:[0,1]
    v_pk_add_f32 v[148:149], v[142:143], v[148:149] neg_lo:[0,1] neg_hi:[0,1]
    v_cvt_pk_bf16_f32 v63, v144, v145
    v_cvt_pk_bf16_f32 v55, v146, v147
    v_cvt_pk_bf16_f32 v71, v148, v149
    ds_read_b128 v[100:103], v15 offset:64
    ds_read_b128 v[32:35], v1 offset:544
    ds_read_b128 v[36:39], v1 offset:560
    s_waitcnt lgkmcnt(3)
    v_pk_mul_f32 v[128:129], v[24:25], v[16:17]
    v_pk_mul_f32 v[136:137], v[24:25], v[18:19]
    v_mfma_f32_16x16x32_bf16 v[112:115], v[48:51], v[56:59], v[112:115]
    v_exp_f32 v130, v128
    v_exp_f32 v138, v136
    v_fract_f32 v129, v129
    v_fract_f32 v137, v137
    v_fma_f32 v129, v26, v17, v129
    v_fma_f32 v137, v26, v19, v137
    v_mfma_f32_16x16x32_bf16 v[120:123], v[72:75], v[56:59], v[120:123]
    v_cos_f32 v132, v129
    v_sin_f32 v133, v129
    v_cos_f32 v140, v137
    v_sin_f32 v141, v137
    v_pk_mul_f32 v[132:133], v[132:133], v[130:131] op_sel:[0,0] op_sel_hi:[1,0]
    v_pk_mul_f32 v[140:141], v[140:141], v[138:139] op_sel:[0,0] op_sel_hi:[1,0]
    v_pk_mul_f32 v[128:129], v[132:133], v[28:29] op_sel:[0,0] op_sel_hi:[1,0]
    v_pk_mul_f32 v[136:137], v[140:141], v[30:31] op_sel:[0,0] op_sel_hi:[1,0]
    v_pk_fma_f32 v[134:135], v[132:133], v[28:29], v[128:129] op_sel:[1,1,0] op_sel_hi:[0,1,1] neg_lo:[1,0,0]
    v_pk_fma_f32 v[142:143], v[140:141], v[30:31], v[136:137] op_sel:[1,1,0] op_sel_hi:[0,1,1] neg_lo:[1,0,0]
    v_cvt_pk_bf16_f32 v84, v140, v141
    v_cvt_pk_bf16_f32 v76, v134, v135
    v_cvt_pk_bf16_f32 v92, v142, v143
    v_lshlrev_b32 v144, 16, v84
    v_and_b32 v145, 0xffff0000, v84
    v_lshlrev_b32 v146, 16, v76
    v_and_b32 v147, 0xffff0000, v76
    v_lshlrev_b32 v148, 16, v92
    v_and_b32 v149, 0xffff0000, v92
    v_pk_add_f32 v[144:145], v[140:141], v[144:145] neg_lo:[0,1] neg_hi:[0,1]
    v_pk_add_f32 v[146:147], v[134:135], v[146:147] neg_lo:[0,1] neg_hi:[0,1]
    v_pk_add_f32 v[148:149], v[142:143], v[148:149] neg_lo:[0,1] neg_hi:[0,1]
    v_cvt_pk_bf16_f32 v88, v144, v145
    v_cvt_pk_bf16_f32 v80, v146, v147
    v_cvt_pk_bf16_f32 v96, v148, v149
    ds_read_b128 v[24:27], v1 offset:576
    ds_read_b128 v[28:31], v1 offset:592
    s_waitcnt lgkmcnt(2)
    v_pk_mul_f32 v[128:129], v[32:33], v[16:17]
    v_pk_mul_f32 v[136:137], v[32:33], v[18:19]
    v_mfma_f32_16x16x32_bf16 v[112:115], v[48:51], v[60:63], v[112:115]
    v_exp_f32 v130, v128
    v_exp_f32 v138, v136
    v_fract_f32 v129, v129
    v_fract_f32 v137, v137
    v_fma_f32 v129, v34, v17, v129
    v_fma_f32 v137, v34, v19, v137
    v_mfma_f32_16x16x32_bf16 v[120:123], v[72:75], v[60:63], v[120:123]
    v_cos_f32 v132, v129
    v_sin_f32 v133, v129
    v_cos_f32 v140, v137
    v_sin_f32 v141, v137
    v_pk_mul_f32 v[132:133], v[132:133], v[130:131] op_sel:[0,0] op_sel_hi:[1,0]
    v_pk_mul_f32 v[140:141], v[140:141], v[138:139] op_sel:[0,0] op_sel_hi:[1,0]
    v_pk_mul_f32 v[128:129], v[132:133], v[36:37] op_sel:[0,0] op_sel_hi:[1,0]
    v_pk_mul_f32 v[136:137], v[140:141], v[38:39] op_sel:[0,0] op_sel_hi:[1,0]
    v_pk_fma_f32 v[134:135], v[132:133], v[36:37], v[128:129] op_sel:[1,1,0] op_sel_hi:[0,1,1] neg_lo:[1,0,0]
    v_pk_fma_f32 v[142:143], v[140:141], v[38:39], v[136:137] op_sel:[1,1,0] op_sel_hi:[0,1,1] neg_lo:[1,0,0]
    v_mfma_f32_16x16x32_bf16 v[112:115], v[52:55], v[56:59], v[112:115]
    v_cvt_pk_bf16_f32 v85, v140, v141
    v_cvt_pk_bf16_f32 v77, v134, v135
    v_cvt_pk_bf16_f32 v93, v142, v143
    v_lshlrev_b32 v144, 16, v85
    v_and_b32 v145, 0xffff0000, v85
    v_lshlrev_b32 v146, 16, v77
    v_and_b32 v147, 0xffff0000, v77
    v_lshlrev_b32 v148, 16, v93
    v_and_b32 v149, 0xffff0000, v93
    v_pk_add_f32 v[144:145], v[140:141], v[144:145] neg_lo:[0,1] neg_hi:[0,1]
    v_pk_add_f32 v[146:147], v[134:135], v[146:147] neg_lo:[0,1] neg_hi:[0,1]
    v_pk_add_f32 v[148:149], v[142:143], v[148:149] neg_lo:[0,1] neg_hi:[0,1]
    v_cvt_pk_bf16_f32 v89, v144, v145
    v_cvt_pk_bf16_f32 v81, v146, v147
    v_cvt_pk_bf16_f32 v97, v148, v149
    ds_read_b128 v[32:35], v1 offset:608
    ds_read_b128 v[36:39], v1 offset:624
    s_waitcnt lgkmcnt(2)
    v_pk_mul_f32 v[128:129], v[24:25], v[16:17]
    v_pk_mul_f32 v[136:137], v[24:25], v[18:19]
    v_mfma_f32_16x16x32_bf16 v[116:119], v[48:51], v[64:67], v[116:119]
    v_exp_f32 v130, v128
    v_exp_f32 v138, v136
    v_fract_f32 v129, v129
    v_fract_f32 v137, v137
    v_fma_f32 v129, v26, v17, v129
    v_fma_f32 v137, v26, v19, v137
    v_mfma_f32_16x16x32_bf16 v[124:127], v[72:75], v[64:67], v[124:127]
    v_cos_f32 v132, v129
    v_sin_f32 v133, v129
    v_cos_f32 v140, v137
    v_sin_f32 v141, v137
    v_pk_mul_f32 v[132:133], v[132:133], v[130:131] op_sel:[0,0] op_sel_hi:[1,0]
    v_pk_mul_f32 v[140:141], v[140:141], v[138:139] op_sel:[0,0] op_sel_hi:[1,0]
    v_pk_mul_f32 v[128:129], v[132:133], v[28:29] op_sel:[0,0] op_sel_hi:[1,0]
    v_pk_mul_f32 v[136:137], v[140:141], v[30:31] op_sel:[0,0] op_sel_hi:[1,0]
    v_pk_fma_f32 v[134:135], v[132:133], v[28:29], v[128:129] op_sel:[1,1,0] op_sel_hi:[0,1,1] neg_lo:[1,0,0]
    v_pk_fma_f32 v[142:143], v[140:141], v[30:31], v[136:137] op_sel:[1,1,0] op_sel_hi:[0,1,1] neg_lo:[1,0,0]
    v_cvt_pk_bf16_f32 v86, v140, v141
    v_cvt_pk_bf16_f32 v78, v134, v135
    v_cvt_pk_bf16_f32 v94, v142, v143
    v_lshlrev_b32 v144, 16, v86
    v_and_b32 v145, 0xffff0000, v86
    v_lshlrev_b32 v146, 16, v78
    v_and_b32 v147, 0xffff0000, v78
    v_lshlrev_b32 v148, 16, v94
    v_and_b32 v149, 0xffff0000, v94
    v_pk_add_f32 v[144:145], v[140:141], v[144:145] neg_lo:[0,1] neg_hi:[0,1]
    v_pk_add_f32 v[146:147], v[134:135], v[146:147] neg_lo:[0,1] neg_hi:[0,1]
    v_pk_add_f32 v[148:149], v[142:143], v[148:149] neg_lo:[0,1] neg_hi:[0,1]
    v_cvt_pk_bf16_f32 v90, v144, v145
    v_cvt_pk_bf16_f32 v82, v146, v147
    v_cvt_pk_bf16_f32 v98, v148, v149
    ds_read_b128 v[24:27], v1 offset:1024
    ds_read_b128 v[28:31], v1 offset:1040
    s_waitcnt lgkmcnt(2)
    v_pk_mul_f32 v[128:129], v[32:33], v[16:17]
    v_pk_mul_f32 v[136:137], v[32:33], v[18:19]
    v_mfma_f32_16x16x32_bf16 v[116:119], v[48:51], v[68:71], v[116:119]
    v_exp_f32 v130, v128
    v_exp_f32 v138, v136
    v_fract_f32 v129, v129
    v_fract_f32 v137, v137
    v_fma_f32 v129, v34, v17, v129
    v_fma_f32 v137, v34, v19, v137
    v_mfma_f32_16x16x32_bf16 v[124:127], v[72:75], v[68:71], v[124:127]
    v_cos_f32 v132, v129
    v_sin_f32 v133, v129
    v_cos_f32 v140, v137
    v_sin_f32 v141, v137
    v_pk_mul_f32 v[132:133], v[132:133], v[130:131] op_sel:[0,0] op_sel_hi:[1,0]
    v_pk_mul_f32 v[140:141], v[140:141], v[138:139] op_sel:[0,0] op_sel_hi:[1,0]
    v_pk_mul_f32 v[128:129], v[132:133], v[36:37] op_sel:[0,0] op_sel_hi:[1,0]
    v_pk_mul_f32 v[136:137], v[140:141], v[38:39] op_sel:[0,0] op_sel_hi:[1,0]
    v_pk_fma_f32 v[134:135], v[132:133], v[36:37], v[128:129] op_sel:[1,1,0] op_sel_hi:[0,1,1] neg_lo:[1,0,0]
    v_pk_fma_f32 v[142:143], v[140:141], v[38:39], v[136:137] op_sel:[1,1,0] op_sel_hi:[0,1,1] neg_lo:[1,0,0]
    v_mfma_f32_16x16x32_bf16 v[116:119], v[52:55], v[64:67], v[116:119]
    v_cvt_pk_bf16_f32 v87, v140, v141
    v_cvt_pk_bf16_f32 v79, v134, v135
    v_cvt_pk_bf16_f32 v95, v142, v143
    v_lshlrev_b32 v144, 16, v87
    v_and_b32 v145, 0xffff0000, v87
    v_lshlrev_b32 v146, 16, v79
    v_and_b32 v147, 0xffff0000, v79
    v_lshlrev_b32 v148, 16, v95
    v_and_b32 v149, 0xffff0000, v95
    v_pk_add_f32 v[144:145], v[140:141], v[144:145] neg_lo:[0,1] neg_hi:[0,1]
    v_pk_add_f32 v[146:147], v[134:135], v[146:147] neg_lo:[0,1] neg_hi:[0,1]
    v_pk_add_f32 v[148:149], v[142:143], v[148:149] neg_lo:[0,1] neg_hi:[0,1]
    v_cvt_pk_bf16_f32 v91, v144, v145
    v_cvt_pk_bf16_f32 v83, v146, v147
    v_cvt_pk_bf16_f32 v99, v148, v149
    ds_read_b128 v[72:75], v15 offset:128
    ds_read_b128 v[32:35], v1 offset:1056
    ds_read_b128 v[36:39], v1 offset:1072
    s_waitcnt lgkmcnt(3)
    v_pk_mul_f32 v[128:129], v[24:25], v[16:17]
    v_pk_mul_f32 v[136:137], v[24:25], v[18:19]
    v_mfma_f32_16x16x32_bf16 v[112:115], v[76:79], v[84:87], v[112:115]
    v_exp_f32 v130, v128
    v_exp_f32 v138, v136
    v_fract_f32 v129, v129
    v_fract_f32 v137, v137
    v_fma_f32 v129, v26, v17, v129
    v_fma_f32 v137, v26, v19, v137
    v_mfma_f32_16x16x32_bf16 v[120:123], v[100:103], v[84:87], v[120:123]
    v_cos_f32 v132, v129
    v_sin_f32 v133, v129
    v_cos_f32 v140, v137
    v_sin_f32 v141, v137
    v_pk_mul_f32 v[132:133], v[132:133], v[130:131] op_sel:[0,0] op_sel_hi:[1,0]
    v_pk_mul_f32 v[140:141], v[140:141], v[138:139] op_sel:[0,0] op_sel_hi:[1,0]
    v_pk_mul_f32 v[128:129], v[132:133], v[28:29] op_sel:[0,0] op_sel_hi:[1,0]
    v_pk_mul_f32 v[136:137], v[140:141], v[30:31] op_sel:[0,0] op_sel_hi:[1,0]
    v_pk_fma_f32 v[134:135], v[132:133], v[28:29], v[128:129] op_sel:[1,1,0] op_sel_hi:[0,1,1] neg_lo:[1,0,0]
    v_pk_fma_f32 v[142:143], v[140:141], v[30:31], v[136:137] op_sel:[1,1,0] op_sel_hi:[0,1,1] neg_lo:[1,0,0]
    v_cvt_pk_bf16_f32 v56, v140, v141
    v_cvt_pk_bf16_f32 v48, v134, v135
    v_cvt_pk_bf16_f32 v64, v142, v143
    v_lshlrev_b32 v144, 16, v56
    v_and_b32 v145, 0xffff0000, v56
    v_lshlrev_b32 v146, 16, v48
    v_and_b32 v147, 0xffff0000, v48
    v_lshlrev_b32 v148, 16, v64
    v_and_b32 v149, 0xffff0000, v64
    v_pk_add_f32 v[144:145], v[140:141], v[144:145] neg_lo:[0,1] neg_hi:[0,1]
    v_pk_add_f32 v[146:147], v[134:135], v[146:147] neg_lo:[0,1] neg_hi:[0,1]
    v_pk_add_f32 v[148:149], v[142:143], v[148:149] neg_lo:[0,1] neg_hi:[0,1]
    v_cvt_pk_bf16_f32 v60, v144, v145
    v_cvt_pk_bf16_f32 v52, v146, v147
    v_cvt_pk_bf16_f32 v68, v148, v149
    ds_read_b128 v[24:27], v1 offset:1088
    ds_read_b128 v[28:31], v1 offset:1104
    s_waitcnt lgkmcnt(2)
    v_pk_mul_f32 v[128:129], v[32:33], v[16:17]
    v_pk_mul_f32 v[136:137], v[32:33], v[18:19]
    v_mfma_f32_16x16x32_bf16 v[112:115], v[76:79], v[88:91], v[112:115]
    v_exp_f32 v130, v128
    v_exp_f32 v138, v136
    v_fract_f32 v129, v129
    v_fract_f32 v137, v137
    v_fma_f32 v129, v34, v17, v129
    v_fma_f32 v137, v34, v19, v137
    v_mfma_f32_16x16x32_bf16 v[120:123], v[100:103], v[88:91], v[120:123]
    v_cos_f32 v132, v129
    v_sin_f32 v133, v129
    v_cos_f32 v140, v137
    v_sin_f32 v141, v137
    v_pk_mul_f32 v[132:133], v[132:133], v[130:131] op_sel:[0,0] op_sel_hi:[1,0]
    v_pk_mul_f32 v[140:141], v[140:141], v[138:139] op_sel:[0,0] op_sel_hi:[1,0]
    v_pk_mul_f32 v[128:129], v[132:133], v[36:37] op_sel:[0,0] op_sel_hi:[1,0]
    v_pk_mul_f32 v[136:137], v[140:141], v[38:39] op_sel:[0,0] op_sel_hi:[1,0]
    v_pk_fma_f32 v[134:135], v[132:133], v[36:37], v[128:129] op_sel:[1,1,0] op_sel_hi:[0,1,1] neg_lo:[1,0,0]
    v_pk_fma_f32 v[142:143], v[140:141], v[38:39], v[136:137] op_sel:[1,1,0] op_sel_hi:[0,1,1] neg_lo:[1,0,0]
    v_mfma_f32_16x16x32_bf16 v[112:115], v[80:83], v[84:87], v[112:115]
    v_cvt_pk_bf16_f32 v57, v140, v141
    v_cvt_pk_bf16_f32 v49, v134, v135
    v_cvt_pk_bf16_f32 v65, v142, v143
    v_lshlrev_b32 v144, 16, v57
    v_and_b32 v145, 0xffff0000, v57
    v_lshlrev_b32 v146, 16, v49
    v_and_b32 v147, 0xffff0000, v49
    v_lshlrev_b32 v148, 16, v65
    v_and_b32 v149, 0xffff0000, v65
    v_pk_add_f32 v[144:145], v[140:141], v[144:145] neg_lo:[0,1] neg_hi:[0,1]
    v_pk_add_f32 v[146:147], v[134:135], v[146:147] neg_lo:[0,1] neg_hi:[0,1]
    v_pk_add_f32 v[148:149], v[142:143], v[148:149] neg_lo:[0,1] neg_hi:[0,1]
    v_cvt_pk_bf16_f32 v61, v144, v145
    v_cvt_pk_bf16_f32 v53, v146, v147
    v_cvt_pk_bf16_f32 v69, v148, v149
    ds_read_b128 v[32:35], v1 offset:1120
    ds_read_b128 v[36:39], v1 offset:1136
    s_waitcnt lgkmcnt(2)
    v_pk_mul_f32 v[128:129], v[24:25], v[16:17]
    v_pk_mul_f32 v[136:137], v[24:25], v[18:19]
    v_mfma_f32_16x16x32_bf16 v[116:119], v[76:79], v[92:95], v[116:119]
    v_exp_f32 v130, v128
    v_exp_f32 v138, v136
    v_fract_f32 v129, v129
    v_fract_f32 v137, v137
    v_fma_f32 v129, v26, v17, v129
    v_fma_f32 v137, v26, v19, v137
    v_mfma_f32_16x16x32_bf16 v[124:127], v[100:103], v[92:95], v[124:127]
    v_cos_f32 v132, v129
    v_sin_f32 v133, v129
    v_cos_f32 v140, v137
    v_sin_f32 v141, v137
    v_pk_mul_f32 v[132:133], v[132:133], v[130:131] op_sel:[0,0] op_sel_hi:[1,0]
    v_pk_mul_f32 v[140:141], v[140:141], v[138:139] op_sel:[0,0] op_sel_hi:[1,0]
    v_pk_mul_f32 v[128:129], v[132:133], v[28:29] op_sel:[0,0] op_sel_hi:[1,0]
    v_pk_mul_f32 v[136:137], v[140:141], v[30:31] op_sel:[0,0] op_sel_hi:[1,0]
    v_pk_fma_f32 v[134:135], v[132:133], v[28:29], v[128:129] op_sel:[1,1,0] op_sel_hi:[0,1,1] neg_lo:[1,0,0]
    v_pk_fma_f32 v[142:143], v[140:141], v[30:31], v[136:137] op_sel:[1,1,0] op_sel_hi:[0,1,1] neg_lo:[1,0,0]
    v_cvt_pk_bf16_f32 v58, v140, v141
    v_cvt_pk_bf16_f32 v50, v134, v135
    v_cvt_pk_bf16_f32 v66, v142, v143
    v_lshlrev_b32 v144, 16, v58
    v_and_b32 v145, 0xffff0000, v58
    v_lshlrev_b32 v146, 16, v50
    v_and_b32 v147, 0xffff0000, v50
    v_lshlrev_b32 v148, 16, v66
    v_and_b32 v149, 0xffff0000, v66
    v_pk_add_f32 v[144:145], v[140:141], v[144:145] neg_lo:[0,1] neg_hi:[0,1]
    v_pk_add_f32 v[146:147], v[134:135], v[146:147] neg_lo:[0,1] neg_hi:[0,1]
    v_pk_add_f32 v[148:149], v[142:143], v[148:149] neg_lo:[0,1] neg_hi:[0,1]
    v_cvt_pk_bf16_f32 v62, v144, v145
    v_cvt_pk_bf16_f32 v54, v146, v147
    v_cvt_pk_bf16_f32 v70, v148, v149
    ds_read_b128 v[24:27], v1 offset:1536
    ds_read_b128 v[28:31], v1 offset:1552
    s_waitcnt lgkmcnt(2)
    v_pk_mul_f32 v[128:129], v[32:33], v[16:17]
    v_pk_mul_f32 v[136:137], v[32:33], v[18:19]
    v_mfma_f32_16x16x32_bf16 v[116:119], v[76:79], v[96:99], v[116:119]
    v_exp_f32 v130, v128
    v_exp_f32 v138, v136
    v_fract_f32 v129, v129
    v_fract_f32 v137, v137
    v_fma_f32 v129, v34, v17, v129
    v_fma_f32 v137, v34, v19, v137
    v_mfma_f32_16x16x32_bf16 v[124:127], v[100:103], v[96:99], v[124:127]
    v_cos_f32 v132, v129
    v_sin_f32 v133, v129
    v_cos_f32 v140, v137
    v_sin_f32 v141, v137
    v_pk_mul_f32 v[132:133], v[132:133], v[130:131] op_sel:[0,0] op_sel_hi:[1,0]
    v_pk_mul_f32 v[140:141], v[140:141], v[138:139] op_sel:[0,0] op_sel_hi:[1,0]
    v_pk_mul_f32 v[128:129], v[132:133], v[36:37] op_sel:[0,0] op_sel_hi:[1,0]
    v_pk_mul_f32 v[136:137], v[140:141], v[38:39] op_sel:[0,0] op_sel_hi:[1,0]
    v_pk_fma_f32 v[134:135], v[132:133], v[36:37], v[128:129] op_sel:[1,1,0] op_sel_hi:[0,1,1] neg_lo:[1,0,0]
    v_pk_fma_f32 v[142:143], v[140:141], v[38:39], v[136:137] op_sel:[1,1,0] op_sel_hi:[0,1,1] neg_lo:[1,0,0]
    v_mfma_f32_16x16x32_bf16 v[116:119], v[80:83], v[92:95], v[116:119]
    v_cvt_pk_bf16_f32 v59, v140, v141
    v_cvt_pk_bf16_f32 v51, v134, v135
    v_cvt_pk_bf16_f32 v67, v142, v143
    v_lshlrev_b32 v144, 16, v59
    v_and_b32 v145, 0xffff0000, v59
    v_lshlrev_b32 v146, 16, v51
    v_and_b32 v147, 0xffff0000, v51
    v_lshlrev_b32 v148, 16, v67
    v_and_b32 v149, 0xffff0000, v67
    v_pk_add_f32 v[144:145], v[140:141], v[144:145] neg_lo:[0,1] neg_hi:[0,1]
    v_pk_add_f32 v[146:147], v[134:135], v[146:147] neg_lo:[0,1] neg_hi:[0,1]
    v_pk_add_f32 v[148:149], v[142:143], v[148:149] neg_lo:[0,1] neg_hi:[0,1]
    v_cvt_pk_bf16_f32 v63, v144, v145
    v_cvt_pk_bf16_f32 v55, v146, v147
    v_cvt_pk_bf16_f32 v71, v148, v149
    buffer_load_dword v4, v3, s[60:63], 0 offen sc1
    ds_read_b128 v[100:103], v15 offset:192
    ds_read_b128 v[32:35], v1 offset:1568
    ds_read_b128 v[36:39], v1 offset:1584
    s_waitcnt lgkmcnt(3)
    v_pk_mul_f32 v[128:129], v[24:25], v[16:17]
    v_pk_mul_f32 v[136:137], v[24:25], v[18:19]
    v_mfma_f32_16x16x32_bf16 v[112:115], v[48:51], v[56:59], v[112:115]
    v_exp_f32 v130, v128
    v_exp_f32 v138, v136
    v_fract_f32 v129, v129
    v_fract_f32 v137, v137
    v_fma_f32 v129, v26, v17, v129
    v_fma_f32 v137, v26, v19, v137
    v_mfma_f32_16x16x32_bf16 v[120:123], v[72:75], v[56:59], v[120:123]
    v_cos_f32 v132, v129
    v_sin_f32 v133, v129
    v_cos_f32 v140, v137
    v_sin_f32 v141, v137
    v_pk_mul_f32 v[132:133], v[132:133], v[130:131] op_sel:[0,0] op_sel_hi:[1,0]
    v_pk_mul_f32 v[140:141], v[140:141], v[138:139] op_sel:[0,0] op_sel_hi:[1,0]
    v_pk_mul_f32 v[128:129], v[132:133], v[28:29] op_sel:[0,0] op_sel_hi:[1,0]
    v_pk_mul_f32 v[136:137], v[140:141], v[30:31] op_sel:[0,0] op_sel_hi:[1,0]
    v_pk_fma_f32 v[134:135], v[132:133], v[28:29], v[128:129] op_sel:[1,1,0] op_sel_hi:[0,1,1] neg_lo:[1,0,0]
    v_pk_fma_f32 v[142:143], v[140:141], v[30:31], v[136:137] op_sel:[1,1,0] op_sel_hi:[0,1,1] neg_lo:[1,0,0]
    v_cvt_pk_bf16_f32 v84, v140, v141
    v_cvt_pk_bf16_f32 v76, v134, v135
    v_cvt_pk_bf16_f32 v92, v142, v143
    v_lshlrev_b32 v144, 16, v84
    v_and_b32 v145, 0xffff0000, v84
    v_lshlrev_b32 v146, 16, v76
    v_and_b32 v147, 0xffff0000, v76
    v_lshlrev_b32 v148, 16, v92
    v_and_b32 v149, 0xffff0000, v92
    v_pk_add_f32 v[144:145], v[140:141], v[144:145] neg_lo:[0,1] neg_hi:[0,1]
    v_pk_add_f32 v[146:147], v[134:135], v[146:147] neg_lo:[0,1] neg_hi:[0,1]
    v_pk_add_f32 v[148:149], v[142:143], v[148:149] neg_lo:[0,1] neg_hi:[0,1]
    v_cvt_pk_bf16_f32 v88, v144, v145
    v_cvt_pk_bf16_f32 v80, v146, v147
    v_cvt_pk_bf16_f32 v96, v148, v149
    ds_read_b128 v[24:27], v1 offset:1600
    ds_read_b128 v[28:31], v1 offset:1616
    s_waitcnt lgkmcnt(2)
    v_pk_mul_f32 v[128:129], v[32:33], v[16:17]
    v_pk_mul_f32 v[136:137], v[32:33], v[18:19]
    v_mfma_f32_16x16x32_bf16 v[112:115], v[48:51], v[60:63], v[112:115]
    v_exp_f32 v130, v128
    v_exp_f32 v138, v136
    v_fract_f32 v129, v129
    v_fract_f32 v137, v137
    v_fma_f32 v129, v34, v17, v129
    v_fma_f32 v137, v34, v19, v137
    v_mfma_f32_16x16x32_bf16 v[120:123], v[72:75], v[60:63], v[120:123]
    v_cos_f32 v132, v129
    v_sin_f32 v133, v129
    v_cos_f32 v140, v137
    v_sin_f32 v141, v137
    v_pk_mul_f32 v[132:133], v[132:133], v[130:131] op_sel:[0,0] op_sel_hi:[1,0]
    v_pk_mul_f32 v[140:141], v[140:141], v[138:139] op_sel:[0,0] op_sel_hi:[1,0]
    v_pk_mul_f32 v[128:129], v[132:133], v[36:37] op_sel:[0,0] op_sel_hi:[1,0]
    v_pk_mul_f32 v[136:137], v[140:141], v[38:39] op_sel:[0,0] op_sel_hi:[1,0]
    v_pk_fma_f32 v[134:135], v[132:133], v[36:37], v[128:129] op_sel:[1,1,0] op_sel_hi:[0,1,1] neg_lo:[1,0,0]
    v_pk_fma_f32 v[142:143], v[140:141], v[38:39], v[136:137] op_sel:[1,1,0] op_sel_hi:[0,1,1] neg_lo:[1,0,0]
    v_mfma_f32_16x16x32_bf16 v[112:115], v[52:55], v[56:59], v[112:115]
    v_cvt_pk_bf16_f32 v85, v140, v141
    v_cvt_pk_bf16_f32 v77, v134, v135
    v_cvt_pk_bf16_f32 v93, v142, v143
    v_lshlrev_b32 v144, 16, v85
    v_and_b32 v145, 0xffff0000, v85
    v_lshlrev_b32 v146, 16, v77
    v_and_b32 v147, 0xffff0000, v77
    v_lshlrev_b32 v148, 16, v93
    v_and_b32 v149, 0xffff0000, v93
    v_pk_add_f32 v[144:145], v[140:141], v[144:145] neg_lo:[0,1] neg_hi:[0,1]
    v_pk_add_f32 v[146:147], v[134:135], v[146:147] neg_lo:[0,1] neg_hi:[0,1]
    v_pk_add_f32 v[148:149], v[142:143], v[148:149] neg_lo:[0,1] neg_hi:[0,1]
    v_cvt_pk_bf16_f32 v89, v144, v145
    v_cvt_pk_bf16_f32 v81, v146, v147
    v_cvt_pk_bf16_f32 v97, v148, v149
    ds_read_b128 v[32:35], v1 offset:1632
    ds_read_b128 v[36:39], v1 offset:1648
    s_waitcnt lgkmcnt(2)
    v_pk_mul_f32 v[128:129], v[24:25], v[16:17]
    v_pk_mul_f32 v[136:137], v[24:25], v[18:19]
    v_mfma_f32_16x16x32_bf16 v[116:119], v[48:51], v[64:67], v[116:119]
    v_exp_f32 v130, v128
    v_exp_f32 v138, v136
    v_fract_f32 v129, v129
    v_fract_f32 v137, v137
    v_fma_f32 v129, v26, v17, v129
    v_fma_f32 v137, v26, v19, v137
    v_mfma_f32_16x16x32_bf16 v[124:127], v[72:75], v[64:67], v[124:127]
    v_cos_f32 v132, v129
    v_sin_f32 v133, v129
    v_cos_f32 v140, v137
    v_sin_f32 v141, v137
    v_pk_mul_f32 v[132:133], v[132:133], v[130:131] op_sel:[0,0] op_sel_hi:[1,0]
    v_pk_mul_f32 v[140:141], v[140:141], v[138:139] op_sel:[0,0] op_sel_hi:[1,0]
    v_pk_mul_f32 v[128:129], v[132:133], v[28:29] op_sel:[0,0] op_sel_hi:[1,0]
    v_pk_mul_f32 v[136:137], v[140:141], v[30:31] op_sel:[0,0] op_sel_hi:[1,0]
    v_pk_fma_f32 v[134:135], v[132:133], v[28:29], v[128:129] op_sel:[1,1,0] op_sel_hi:[0,1,1] neg_lo:[1,0,0]
    v_pk_fma_f32 v[142:143], v[140:141], v[30:31], v[136:137] op_sel:[1,1,0] op_sel_hi:[0,1,1] neg_lo:[1,0,0]
    v_cvt_pk_bf16_f32 v86, v140, v141
    v_cvt_pk_bf16_f32 v78, v134, v135
    v_cvt_pk_bf16_f32 v94, v142, v143
    v_lshlrev_b32 v144, 16, v86
    v_and_b32 v145, 0xffff0000, v86
    v_lshlrev_b32 v146, 16, v78
    v_and_b32 v147, 0xffff0000, v78
    v_lshlrev_b32 v148, 16, v94
    v_and_b32 v149, 0xffff0000, v94
    v_pk_add_f32 v[144:145], v[140:141], v[144:145] neg_lo:[0,1] neg_hi:[0,1]
    v_pk_add_f32 v[146:147], v[134:135], v[146:147] neg_lo:[0,1] neg_hi:[0,1]
    v_pk_add_f32 v[148:149], v[142:143], v[148:149] neg_lo:[0,1] neg_hi:[0,1]
    v_cvt_pk_bf16_f32 v90, v144, v145
    v_cvt_pk_bf16_f32 v82, v146, v147
    v_cvt_pk_bf16_f32 v98, v148, v149
    ds_read_b128 v[24:27], v1 offset:2048
    ds_read_b128 v[28:31], v1 offset:2064
    s_waitcnt lgkmcnt(2)
    v_pk_mul_f32 v[128:129], v[32:33], v[16:17]
    v_pk_mul_f32 v[136:137], v[32:33], v[18:19]
    v_mfma_f32_16x16x32_bf16 v[116:119], v[48:51], v[68:71], v[116:119]
    v_exp_f32 v130, v128
    v_exp_f32 v138, v136
    v_fract_f32 v129, v129
    v_fract_f32 v137, v137
    v_fma_f32 v129, v34, v17, v129
    v_fma_f32 v137, v34, v19, v137
    v_mfma_f32_16x16x32_bf16 v[124:127], v[72:75], v[68:71], v[124:127]
    v_cos_f32 v132, v129
    v_sin_f32 v133, v129
    v_cos_f32 v140, v137
    v_sin_f32 v141, v137
    v_pk_mul_f32 v[132:133], v[132:133], v[130:131] op_sel:[0,0] op_sel_hi:[1,0]
    v_pk_mul_f32 v[140:141], v[140:141], v[138:139] op_sel:[0,0] op_sel_hi:[1,0]
    v_pk_mul_f32 v[128:129], v[132:133], v[36:37] op_sel:[0,0] op_sel_hi:[1,0]
    v_pk_mul_f32 v[136:137], v[140:141], v[38:39] op_sel:[0,0] op_sel_hi:[1,0]
    v_pk_fma_f32 v[134:135], v[132:133], v[36:37], v[128:129] op_sel:[1,1,0] op_sel_hi:[0,1,1] neg_lo:[1,0,0]
    v_pk_fma_f32 v[142:143], v[140:141], v[38:39], v[136:137] op_sel:[1,1,0] op_sel_hi:[0,1,1] neg_lo:[1,0,0]
    v_mfma_f32_16x16x32_bf16 v[116:119], v[52:55], v[64:67], v[116:119]
    v_cvt_pk_bf16_f32 v87, v140, v141
    v_cvt_pk_bf16_f32 v79, v134, v135
    v_cvt_pk_bf16_f32 v95, v142, v143
    v_lshlrev_b32 v144, 16, v87
    v_and_b32 v145, 0xffff0000, v87
    v_lshlrev_b32 v146, 16, v79
    v_and_b32 v147, 0xffff0000, v79
    v_lshlrev_b32 v148, 16, v95
    v_and_b32 v149, 0xffff0000, v95
    v_pk_add_f32 v[144:145], v[140:141], v[144:145] neg_lo:[0,1] neg_hi:[0,1]
    v_pk_add_f32 v[146:147], v[134:135], v[146:147] neg_lo:[0,1] neg_hi:[0,1]
    v_pk_add_f32 v[148:149], v[142:143], v[148:149] neg_lo:[0,1] neg_hi:[0,1]
    v_cvt_pk_bf16_f32 v91, v144, v145
    v_cvt_pk_bf16_f32 v83, v146, v147
    v_cvt_pk_bf16_f32 v99, v148, v149
    v_mfma_f32_16x16x32_bf16 v[112:115], v[76:79], v[84:87], v[112:115]
    v_mfma_f32_16x16x32_bf16 v[120:123], v[100:103], v[84:87], v[120:123]
    v_mfma_f32_16x16x32_bf16 v[112:115], v[76:79], v[88:91], v[112:115]
    v_mfma_f32_16x16x32_bf16 v[120:123], v[100:103], v[88:91], v[120:123]
    v_mfma_f32_16x16x32_bf16 v[112:115], v[80:83], v[84:87], v[112:115]
    v_mfma_f32_16x16x32_bf16 v[116:119], v[76:79], v[92:95], v[116:119]
    v_mfma_f32_16x16x32_bf16 v[124:127], v[100:103], v[92:95], v[124:127]
    v_mfma_f32_16x16x32_bf16 v[116:119], v[76:79], v[96:99], v[116:119]
    v_mfma_f32_16x16x32_bf16 v[124:127], v[100:103], v[96:99], v[124:127]
    v_mfma_f32_16x16x32_bf16 v[116:119], v[80:83], v[92:95], v[116:119]
    s_setprio 1
    s_load_dwordx2 s[4:5], s[0:1], 88
    s_mov_b32 s6, 1605632
    s_mov_b32 s7, 0x20000
    s_load_dwordx2 s[8:9], s[0:1], 96
    s_mov_b32 s10, 1605632
    s_mov_b32 s11, 0x20000
    s_load_dwordx2 s[16:17], s[0:1], 104
    s_mov_b32 s18, 1605632
    s_mov_b32 s19, 0x20000
    v_lshrrev_b32 v5, 1, v0
    v_mul_u32_u24 v5, 14336, v5
    v_and_b32 v6, 1, v0
    v_lshl_add_u32 v5, v6, 4, v5
    s_lshl_b32 s12, s3, 5
    s_add_u32 s12, s12, 131072
    s_lshl_b32 s14, s3, 2
    v_mov_b32 v7, s14
    v_lshlrev_b32 v6, 4, v0
    v_readfirstlane_b32 s48, v13
    s_waitcnt vmcnt(0)
    v_readfirstlane_b32 s13, v4
    s_cmp_eq_u32 s13, 0
    s_cbranch_scc1 F1_notyet
    buffer_load_dwordx4 v[80:83], v5, s[32:35], s12 offen sc1
    buffer_load_dword v9, v7, s[32:35], 0 offen offset:0 sc1
    buffer_load_dword v14, v7, s[32:35], 0 offen offset:1792 sc1
F1_notyet:
    v_mov_b32 v140, 0
    v_mov_b32 v141, 0
    v_mov_b32 v142, 0
    v_mov_b32 v143, 0
    ds_write_b32 v154, v112 offset:18432
    ds_write_b32 v154, v113 offset:18436
    ds_write_b32 v155, v114 offset:18440
    ds_write_b32 v155, v115 offset:18444
    ds_write_b32 v156, v116 offset:18432
    ds_write_b32 v156, v117 offset:18436
    ds_write_b32 v157, v118 offset:18440
    ds_write_b32 v157, v119 offset:18444
    v_add_f32 v144, v120, v121
    v_add_f32 v145, v122, v123
    v_add_f32 v146, v124, v125
    v_add_f32 v147, v126, v127
    s_mov_b32 exec_hi, 1
    ds_write_b32 v158, v144 offset:20480
    s_mov_b32 exec_hi, 0
    ds_write_b32 v158, v145 offset:20608
    ds_write_b32 v158, v146 offset:20544
    ds_write_b32 v158, v147 offset:20672
    s_mov_b64 exec, -1
    v_cmp_gt_u32 vcc, 30, v0
    s_and_saveexec_b64 s[46:47], vcc
    ds_write_b128 v6, v[140:143] offset:32768
    ds_write_b128 v6, v[140:143] offset:37376
    v_cmp_gt_u32 vcc, 2, v0
    s_and_b64 exec, exec, vcc
    ds_write_b128 v6, v[140:143] offset:46080
    ds_write_b128 v6, v[140:143] offset:50256
    s_mov_b64 exec, s[46:47]
    v_lshlrev_b32 v20, 5, v11
    v_lshl_add_u32 v20, v12, 4, v20
    v_lshl_add_u32 v20, v13, 7, v20
    v_and_b32 v21, 14, v11
    v_lshlrev_b32 v21, 1, v21
    v_lshlrev_b32 v16, 4, v12
    v_sub_u32 v21, v16, v21
    v_and_b32 v16, 1, v11
    v_mul_u32_u24 v16, 4172, v16
    v_add_u32 v21, v21, v16
    v_add_u32 v21, 42016, v21
    v_lshl_add_u32 v21, v13, 7, v21
    v_add_u32 v22, 1024, v21
    v_add_u32 v23, 2048, v21
    v_add_u32 v24, 3072, v21
    v_sub_u32 v8, 4080, v6
    s_waitcnt lgkmcnt(0)
    s_barrier
    s_cmp_eq_u32 s48, 0
    s_cbranch_scc1 F1_expA
    s_cmp_eq_u32 s48, 1
    s_cbranch_scc1 F1_expB
    v_lshlrev_b32 v28, 2, v0
    v_add_u32 v28, 19968, v28
    v_add_u32 v29, 2656, v28
    v_add_u32 v30, 5312, v28
    v_add_u32 v31, 7968, v28
    ds_read2_b32 v[32:33], v28 offset0:0 offset1:1
    ds_read2_b32 v[34:35], v29 offset0:0 offset1:1
    ds_read2_b32 v[36:37], v30 offset0:0 offset1:1
    ds_read2_b32 v[38:39], v31 offset0:0 offset1:1
    v_and_b32 v16, 1, v0
    v_cmp_eq_u32 vcc, 1, v16
    s_waitcnt lgkmcnt(0)
    v_add_f32 v32, v32, v34
    v_add_f32 v36, v36, v38
    v_add_f32 v33, v33, v35
    v_add_f32 v37, v37, v39
    v_add_f32 v64, v32, v36
    v_add_f32 v69, v33, v37
    v_cndmask_b32_e64 v68, v64, v69, vcc
    v_mov_b32 v65, v64
    v_mov_b32 v66, v64
    v_mov_b32 v67, v64
    v_mov_b32 v70, v69
    v_mov_b32 v71, v69
    s_branch F1_expD
F1_expB:
    v_lshlrev_b32 v28, 3, v0
    v_add_u32 v28, 19456, v28
    v_add_u32 v29, 2656, v28
    v_add_u32 v30, 5312, v28
    v_add_u32 v31, 7968, v28
    ds_read2_b32 v[32:33], v28 offset0:0 offset1:1
    ds_read2_b32 v[34:35], v28 offset0:2 offset1:3
    ds_read2_b32 v[36:37], v29 offset0:0 offset1:1
    ds_read2_b32 v[38:39], v29 offset0:2 offset1:3
    ds_read2_b32 v[40:41], v30 offset0:0 offset1:1
    ds_read2_b32 v[42:43], v30 offset0:2 offset1:3
    ds_read2_b32 v[44:45], v31 offset0:0 offset1:1
    ds_read2_b32 v[46:47], v31 offset0:2 offset1:3
    s_waitcnt lgkmcnt(0)
    v_add_f32 v32, v32, v36
    v_add_f32 v40, v40, v44
    v_add_f32 v33, v33, v37
    v_add_f32 v41, v41, v45
    v_add_f32 v34, v34, v38
    v_add_f32 v42, v42, v46
    v_add_f32 v64, v32, v40
    v_add_f32 v67, v33, v41
    v_add_f32 v70, v34, v42
    v_mov_b32 v65, v64
    v_mov_b32 v66, v64
    v_mov_b32 v68, v67
    v_mov_b32 v69, v67
    v_mov_b32 v71, v70
    s_branch F1_expD
F1_expA:
    v_lshlrev_b32 v28, 5, v0
    v_lshlrev_b32 v16, 4, v0
    v_add_u32 v16, 512, v16
    v_cmp_gt_u32 vcc, 32, v0
    s_nop 1
    v_cndmask_b32_e64 v28, v16, v28, vcc
    v_add_u32 v28, 18432, v28
    v_add_u32 v29, 2656, v28
    v_add_u32 v30, 5312, v28
    v_add_u32 v31, 7968, v28
    ds_read2_b32 v[32:33], v28 offset0:0 offset1:1
    ds_read2_b32 v[34:35], v28 offset0:2 offset1:3
    ds_read2_b32 v[36:37], v28 offset0:4 offset1:5
    ds_read2_b32 v[38:39], v28 offset0:6 offset1:7
    ds_read2_b32 v[40:41], v29 offset0:0 offset1:1
    ds_read2_b32 v[42:43], v29 offset0:2 offset1:3
    ds_read2_b32 v[44:45], v29 offset0:4 offset1:5
    ds_read2_b32 v[46:47], v29 offset0:6 offset1:7
    ds_read2_b32 v[48:49], v30 offset0:0 offset1:1
    ds_read2_b32 v[50:51], v30 offset0:2 offset1:3
    ds_read2_b32 v[52:53], v30 offset0:4 offset1:5
    ds_read2_b32 v[54:55], v30 offset0:6 offset1:7
    ds_read2_b32 v[56:57], v31 offset0:0 offset1:1
    ds_read2_b32 v[58:59], v31 offset0:2 offset1:3
    ds_read2_b32 v[60:61], v31 offset0:4 offset1:5
    ds_read2_b32 v[62:63], v31 offset0:6 offset1:7
    s_waitcnt lgkmcnt(0)
    v_add_f32 v32, v32, v40
    v_add_f32 v48, v48, v56
    v_add_f32 v32, v32, v48
    v_add_f32 v33, v33, v41
    v_add_f32 v49, v49, v57
    v_add_f32 v33, v33, v49
    v_add_f32 v34, v34, v42
    v_add_f32 v50, v50, v58
    v_add_f32 v34, v34, v50
    v_add_f32 v35, v35, v43
    v_add_f32 v51, v51, v59
    v_add_f32 v35, v35, v51
    v_add_f32 v36, v36, v44
    v_add_f32 v52, v52, v60
    v_add_f32 v36, v36, v52
    v_add_f32 v37, v37, v45
    v_add_f32 v53, v53, v61
    v_add_f32 v37, v37, v53
    v_add_f32 v38, v38, v46
    v_add_f32 v54, v54, v62
    v_add_f32 v38, v38, v54
    v_add_f32 v39, v39, v47
    v_add_f32 v55, v55, v63
    v_add_f32 v39, v39, v55
    v_cndmask_b32_e64 v64, v32, v32, vcc
    v_cndmask_b32_e64 v65, v32, v33, vcc
    v_cndmask_b32_e64 v66, v33, v34, vcc
    v_cndmask_b32_e64 v67, v34, v35, vcc
    v_cndmask_b32_e64 v68, v34, v36, vcc
    v_cndmask_b32_e64 v69, v34, v37, vcc
    v_cndmask_b32_e64 v70, v35, v38, vcc
    v_cndmask_b32_e64 v71, v36, v39, vcc
F1_expD:
    v_cvt_pk_bf16_f32 v72, v64, v65
    v_lshlrev_b32 v32, 16, v72
    v_and_b32 v33, 0xffff0000, v72
    v_pk_add_f32 v[32:33], v[64:65], v[32:33] neg_lo:[0,1] neg_hi:[0,1]
    v_cvt_pk_bf16_f32 v76, v32, v33
    v_cvt_pk_bf16_f32 v73, v66, v67
    v_lshlrev_b32 v34, 16, v73
    v_and_b32 v35, 0xffff0000, v73
    v_pk_add_f32 v[34:35], v[66:67], v[34:35] neg_lo:[0,1] neg_hi:[0,1]
    v_cvt_pk_bf16_f32 v77, v34, v35
    v_cvt_pk_bf16_f32 v74, v68, v69
    v_lshlrev_b32 v36, 16, v74
    v_and_b32 v37, 0xffff0000, v74
    v_pk_add_f32 v[36:37], v[68:69], v[36:37] neg_lo:[0,1] neg_hi:[0,1]
    v_cvt_pk_bf16_f32 v78, v36, v37
    v_cvt_pk_bf16_f32 v75, v70, v71
    v_lshlrev_b32 v38, 16, v75
    v_and_b32 v39, 0xffff0000, v75
    v_pk_add_f32 v[38:39], v[70:71], v[38:39] neg_lo:[0,1] neg_hi:[0,1]
    v_cvt_pk_bf16_f32 v79, v38, v39
    ds_write_b128 v6, v[72:75] offset:33248
    ds_write_b128 v6, v[76:79] offset:37856
    s_cmp_lg_u32 s13, 0
    s_cbranch_scc1 F1_ready
    s_setprio 0
    s_mov_b32 s45, 0
F1_poll:
    buffer_load_dword v4, v3, s[60:63], 0 offen sc1
    s_waitcnt vmcnt(0)
    v_readfirstlane_b32 s13, v4
    s_cmp_lg_u32 s13, 0
    s_cbranch_scc1 F1_got
    s_add_u32 s45, s45, 1
    s_cmp_ge_u32 s45, 0x40000
    s_cbranch_scc1 F1_got
    s_sleep 2
    s_branch F1_poll
F1_got:
    s_setprio 2
    buffer_load_dwordx4 v[80:83], v5, s[32:35], s12 offen sc1
    buffer_load_dword v9, v7, s[32:35], 0 offen offset:0 sc1
    buffer_load_dword v14, v7, s[32:35], 0 offen offset:1792 sc1
F1_ready:
    s_waitcnt vmcnt(0)
    v_add_f32 v14, 1.0, v14
    v_cvt_pk_bf16_f32 v15, v14, v14
    v_lshlrev_b32 v14, 16, v15
    v_lshlrev_b32 v48, 16, v80
    v_and_b32 v49, 0xffff0000, v80
    v_lshlrev_b32 v50, 16, v81
    v_and_b32 v51, 0xffff0000, v81
    v_lshlrev_b32 v52, 16, v82
    v_and_b32 v53, 0xffff0000, v82
    v_lshlrev_b32 v54, 16, v83
    v_and_b32 v55, 0xffff0000, v83
    v_mul_f32 v48, v48, v14
    v_mul_f32 v49, v49, v14
    v_cvt_pk_bf16_f32 v15, v48, v49
    v_lshlrev_b32 v48, 16, v15
    v_and_b32 v49, 0xffff0000, v15
    v_add_f32 v48, v48, v9
    v_add_f32 v49, v49, v9
    v_mul_f32 v50, v50, v14
    v_mul_f32 v51, v51, v14
    v_cvt_pk_bf16_f32 v15, v50, v51
    v_lshlrev_b32 v50, 16, v15
    v_and_b32 v51, 0xffff0000, v15
    v_add_f32 v50, v50, v9
    v_add_f32 v51, v51, v9
    v_mul_f32 v52, v52, v14
    v_mul_f32 v53, v53, v14
    v_cvt_pk_bf16_f32 v15, v52, v53
    v_lshlrev_b32 v52, 16, v15
    v_and_b32 v53, 0xffff0000, v15
    v_add_f32 v52, v52, v9
    v_add_f32 v53, v53, v9
    v_mul_f32 v54, v54, v14
    v_mul_f32 v55, v55, v14
    v_cvt_pk_bf16_f32 v15, v54, v55
    v_lshlrev_b32 v54, 16, v15
    v_and_b32 v55, 0xffff0000, v15
    v_add_f32 v54, v54, v9
    v_add_f32 v55, v55, v9
    v_cvt_pk_bf16_f32 v60, v55, v54
    v_cvt_pk_bf16_f32 v61, v53, v52
    v_cvt_pk_bf16_f32 v62, v51, v50
    v_cvt_pk_bf16_f32 v63, v49, v48
    v_cvt_pk_bf16_f32 v65, v54, v53
    v_cvt_pk_bf16_f32 v66, v52, v51
    v_cvt_pk_bf16_f32 v67, v50, v49
    ds_write_b128 v8, v[60:63] offset:46160
    ds_write_b16 v8, v60 offset:41986
    ds_write_b32 v8, v65 offset:41988
    ds_write_b64 v8, v[66:67] offset:41992
    ds_write_b16_d16_hi v8, v63 offset:42000
    v_bfe_u32 v16, v11, 1, 2
    v_xor_b32 v16, v16, v12
    v_lshlrev_b32 v16, 4, v16
    v_lshl_add_u32 v16, v11, 6, v16
    v_lshl_add_u32 v16, v13, 13, v16
    v_and_b32 v4, 1, v0
    v_lshlrev_b32 v4, 1, v4
    v_bfe_u32 v17, v0, 2, 2
    v_xor_b32 v18, v4, v17
    v_xor_b32 v19, 1, v18
    v_lshrrev_b32 v17, 1, v0
    v_lshlrev_b32 v17, 6, v17
    v_lshl_add_u32 v18, v18, 4, v17
    v_lshl_add_u32 v19, v19, 4, v17
    v_mul_u32_u24 v5, 7168, v0
    s_lshl_b32 s12, s3, 4
    s_add_u32 s12, s12, 4194304
    s_and_b32 s22, s2, 7
    s_lshr_b32 s23, s38, 3
    v_lshrrev_b32 v4, 3, v10
    v_and_b32 v7, 7, v10
    v_lshlrev_b32 v7, 6, v7
    v_min_u32 v7, 444, v7
    v_mul_u32_u24 v4, 3584, v4
    v_add_u32 v4, v4, v7
    s_mul_i32 s24, s23, 28672
    s_mul_i32 s25, s22, 448
    s_add_u32 s24, s24, s25
    s_mul_i32 s26, s22, 224
    s_lshl_b32 s25, s23, 2
    s_add_u32 s26, s26, s25
    s_mul_i32 s26, s26, 896
    v_lshlrev_b32 v7, 6, v10
    v_min_u32 v7, 3520, v7
    s_waitcnt lgkmcnt(0)
    s_barrier
    s_setprio 0
    ds_read_b128 v[28:31], v20 offset:32768
    ds_read2_b32 v[96:97], v24 offset0:128 offset1:129
    ds_read2_b32 v[98:99], v24 offset0:130 offset1:131
    ds_read2_b32 v[100:101], v24 offset0:0 offset1:1
    ds_read2_b32 v[102:103], v24 offset0:2 offset1:3
    ds_read2_b32 v[104:105], v23 offset0:128 offset1:129
    ds_read2_b32 v[106:107], v23 offset0:130 offset1:131
    ds_read2_b32 v[108:109], v23 offset0:0 offset1:1
    ds_read2_b32 v[110:111], v23 offset0:2 offset1:3
    ds_read2_b32 v[112:113], v22 offset0:128 offset1:129
    ds_read2_b32 v[114:115], v22 offset0:130 offset1:131
    ds_read2_b32 v[116:117], v22 offset0:0 offset1:1
    ds_read2_b32 v[118:119], v22 offset0:2 offset1:3
    ds_read2_b32 v[120:121], v21 offset0:128 offset1:129
    ds_read2_b32 v[122:123], v21 offset0:130 offset1:131
    ds_read2_b32 v[124:125], v21 offset0:0 offset1:1
    ds_read2_b32 v[126:127], v21 offset0:2 offset1:3
    ds_read_b128 v[32:35], v20 offset:37376
    ds_read_b128 v[36:39], v20 offset:36352
    ds_read_b128 v[40:43], v20 offset:40960
    s_waitcnt lgkmcnt(15)
    v_mfma_f32_16x16x32_bf16 v[64:67], v[96:99], v[28:31], 0
    s_waitcnt lgkmcnt(15)
    v_mfma_f32_16x16x32_bf16 v[68:71], v[100:103], v[28:31], 0
    ds_read_b128 v[44:47], v20 offset:33280
    s_waitcnt lgkmcnt(14)
    v_mfma_f32_16x16x32_bf16 v[72:75], v[104:107], v[28:31], 0
    s_waitcnt lgkmcnt(12)
    v_mfma_f32_16x16x32_bf16 v[76:79], v[108:111], v[28:31], 0
    ds_read_b128 v[48:51], v20 offset:37888
    s_waitcnt lgkmcnt(11)
    v_mfma_f32_16x16x32_bf16 v[80:83], v[112:115], v[28:31], 0
    s_waitcnt lgkmcnt(9)
    v_mfma_f32_16x16x32_bf16 v[84:87], v[116:119], v[28:31], 0
    ds_read_b128 v[52:55], v20 offset:35840
    s_waitcnt lgkmcnt(8)
    v_mfma_f32_16x16x32_bf16 v[88:91], v[120:123], v[28:31], 0
    s_waitcnt lgkmcnt(6)
    v_mfma_f32_16x16x32_bf16 v[92:95], v[124:127], v[28:31], 0
    ds_read_b128 v[56:59], v20 offset:40448
    s_waitcnt lgkmcnt(6)
    v_mfma_f32_16x16x32_bf16 v[64:67], v[96:99], v[32:35], v[64:67]
    v_mfma_f32_16x16x32_bf16 v[68:71], v[100:103], v[32:35], v[68:71]
    ds_read2_b32 v[128:129], v24 offset0:144 offset1:145
    v_mfma_f32_16x16x32_bf16 v[92:95], v[124:127], v[32:35], v[92:95]
    v_mfma_f32_16x16x32_bf16 v[72:75], v[104:107], v[32:35], v[72:75]
    ds_read2_b32 v[130:131], v24 offset0:146 offset1:147
    v_mfma_f32_16x16x32_bf16 v[76:79], v[108:111], v[32:35], v[76:79]
    s_waitcnt lgkmcnt(7)
    v_mfma_f32_16x16x32_bf16 v[92:95], v[96:99], v[36:39], v[92:95]
    ds_read2_b32 v[132:133], v24 offset0:16 offset1:17
    v_mfma_f32_16x16x32_bf16 v[80:83], v[112:115], v[32:35], v[80:83]
    v_mfma_f32_16x16x32_bf16 v[84:87], v[116:119], v[32:35], v[84:87]
    ds_read2_b32 v[134:135], v24 offset0:18 offset1:19
    v_mfma_f32_16x16x32_bf16 v[88:91], v[120:123], v[32:35], v[88:91]
    s_waitcnt lgkmcnt(8)
    v_mfma_f32_16x16x32_bf16 v[92:95], v[96:99], v[40:43], v[92:95]
    s_waitcnt lgkmcnt(7)
    v_mfma_f32_16x16x32_bf16 v[68:71], v[96:99], v[44:47], v[68:71]
    v_mfma_f32_16x16x32_bf16 v[88:91], v[116:119], v[44:47], v[88:91]
    ds_read_b128 v[28:31], v20 offset:33792
    v_mfma_f32_16x16x32_bf16 v[92:95], v[120:123], v[44:47], v[92:95]
    v_mfma_f32_16x16x32_bf16 v[72:75], v[100:103], v[44:47], v[72:75]
    ds_read_b128 v[32:35], v20 offset:38400
    s_waitcnt lgkmcnt(8)
    v_mfma_f32_16x16x32_bf16 v[88:91], v[116:119], v[48:51], v[88:91]
    v_mfma_f32_16x16x32_bf16 v[92:95], v[120:123], v[48:51], v[92:95]
    ds_read_b128 v[36:39], v20 offset:35328
    v_mfma_f32_16x16x32_bf16 v[76:79], v[104:107], v[44:47], v[76:79]
    v_mfma_f32_16x16x32_bf16 v[80:83], v[108:111], v[44:47], v[80:83]
    ds_read_b128 v[40:43], v20 offset:39936
    v_mfma_f32_16x16x32_bf16 v[84:87], v[112:115], v[44:47], v[84:87]
    s_waitcnt lgkmcnt(9)
    v_mfma_f32_16x16x32_bf16 v[88:91], v[96:99], v[52:55], v[88:91]
    ds_read2_b32 v[136:137], v23 offset0:144 offset1:145
    v_mfma_f32_16x16x32_bf16 v[92:95], v[100:103], v[52:55], v[92:95]
    v_mfma_f32_16x16x32_bf16 v[68:71], v[96:99], v[48:51], v[68:71]
    ds_read2_b32 v[138:139], v23 offset0:146 offset1:147
    v_mfma_f32_16x16x32_bf16 v[72:75], v[100:103], v[48:51], v[72:75]
    v_mfma_f32_16x16x32_bf16 v[76:79], v[104:107], v[48:51], v[76:79]
    ds_read2_b32 v[140:141], v23 offset0:16 offset1:17
    v_mfma_f32_16x16x32_bf16 v[80:83], v[108:111], v[48:51], v[80:83]
    v_mfma_f32_16x16x32_bf16 v[84:87], v[112:115], v[48:51], v[84:87]
    ds_read2_b32 v[142:143], v23 offset0:18 offset1:19
    s_waitcnt lgkmcnt(12)
    v_mfma_f32_16x16x32_bf16 v[88:91], v[96:99], v[56:59], v[88:91]
    v_mfma_f32_16x16x32_bf16 v[92:95], v[100:103], v[56:59], v[92:95]
    s_waitcnt lgkmcnt(7)
    v_mfma_f32_16x16x32_bf16 v[84:87], v[108:111], v[28:31], v[84:87]
    v_mfma_f32_16x16x32_bf16 v[88:91], v[112:115], v[28:31], v[88:91]
    ds_read_b128 v[44:47], v20 offset:34304
    v_mfma_f32_16x16x32_bf16 v[92:95], v[116:119], v[28:31], v[92:95]
    s_waitcnt lgkmcnt(7)
    v_mfma_f32_16x16x32_bf16 v[84:87], v[108:111], v[32:35], v[84:87]
    ds_read_b128 v[48:51], v20 offset:38912
    v_mfma_f32_16x16x32_bf16 v[88:91], v[112:115], v[32:35], v[88:91]
    v_mfma_f32_16x16x32_bf16 v[92:95], v[116:119], v[32:35], v[92:95]
    ds_read_b128 v[52:55], v20 offset:34816
    v_mfma_f32_16x16x32_bf16 v[72:75], v[96:99], v[28:31], v[72:75]
    v_mfma_f32_16x16x32_bf16 v[76:79], v[100:103], v[28:31], v[76:79]
    ds_read_b128 v[56:59], v20 offset:39424
    v_mfma_f32_16x16x32_bf16 v[80:83], v[104:107], v[28:31], v[80:83]
    s_waitcnt lgkmcnt(9)
    v_mfma_f32_16x16x32_bf16 v[84:87], v[96:99], v[36:39], v[84:87]
    ds_read2_b32 v[144:145], v22 offset0:144 offset1:145
    v_mfma_f32_16x16x32_bf16 v[88:91], v[100:103], v[36:39], v[88:91]
    v_mfma_f32_16x16x32_bf16 v[92:95], v[104:107], v[36:39], v[92:95]
    ds_read2_b32 v[146:147], v22 offset0:146 offset1:147
    v_mfma_f32_16x16x32_bf16 v[72:75], v[96:99], v[32:35], v[72:75]
    v_mfma_f32_16x16x32_bf16 v[76:79], v[100:103], v[32:35], v[76:79]
    ds_read2_b32 v[148:149], v22 offset0:16 offset1:17
    v_mfma_f32_16x16x32_bf16 v[80:83], v[104:107], v[32:35], v[80:83]
    s_waitcnt lgkmcnt(11)
    v_mfma_f32_16x16x32_bf16 v[84:87], v[96:99], v[40:43], v[84:87]
    ds_read2_b32 v[150:151], v22 offset0:18 offset1:19
    v_mfma_f32_16x16x32_bf16 v[88:91], v[100:103], v[40:43], v[88:91]
    v_mfma_f32_16x16x32_bf16 v[92:95], v[104:107], v[40:43], v[92:95]
    s_waitcnt lgkmcnt(7)
    v_mfma_f32_16x16x32_bf16 v[80:83], v[100:103], v[44:47], v[80:83]
    v_mfma_f32_16x16x32_bf16 v[84:87], v[104:107], v[44:47], v[84:87]
    ds_read_b128 v[28:31], v20 offset:32832
    v_mfma_f32_16x16x32_bf16 v[88:91], v[108:111], v[44:47], v[88:91]
    v_mfma_f32_16x16x32_bf16 v[92:95], v[112:115], v[44:47], v[92:95]
    ds_read_b128 v[32:35], v20 offset:37440
    s_waitcnt lgkmcnt(8)
    v_mfma_f32_16x16x32_bf16 v[80:83], v[100:103], v[48:51], v[80:83]
    v_mfma_f32_16x16x32_bf16 v[84:87], v[104:107], v[48:51], v[84:87]
    ds_read_b128 v[36:39], v20 offset:36416
    v_mfma_f32_16x16x32_bf16 v[88:91], v[108:111], v[48:51], v[88:91]
    v_mfma_f32_16x16x32_bf16 v[92:95], v[112:115], v[48:51], v[92:95]
    ds_read_b128 v[40:43], v20 offset:41024
    v_mfma_f32_16x16x32_bf16 v[76:79], v[96:99], v[44:47], v[76:79]
    s_waitcnt lgkmcnt(9)
    v_mfma_f32_16x16x32_bf16 v[80:83], v[96:99], v[52:55], v[80:83]
    ds_read2_b32 v[152:153], v21 offset0:144 offset1:145
    v_mfma_f32_16x16x32_bf16 v[84:87], v[100:103], v[52:55], v[84:87]
    v_mfma_f32_16x16x32_bf16 v[88:91], v[104:107], v[52:55], v[88:91]
    ds_read2_b32 v[154:155], v21 offset0:146 offset1:147
    v_mfma_f32_16x16x32_bf16 v[92:95], v[108:111], v[52:55], v[92:95]
    v_mfma_f32_16x16x32_bf16 v[76:79], v[96:99], v[48:51], v[76:79]
    ds_read2_b32 v[156:157], v21 offset0:16 offset1:17
    s_waitcnt lgkmcnt(11)
    v_mfma_f32_16x16x32_bf16 v[80:83], v[96:99], v[56:59], v[80:83]
    v_mfma_f32_16x16x32_bf16 v[84:87], v[100:103], v[56:59], v[84:87]
    ds_read2_b32 v[158:159], v21 offset0:18 offset1:19
    v_mfma_f32_16x16x32_bf16 v[88:91], v[104:107], v[56:59], v[88:91]
    v_mfma_f32_16x16x32_bf16 v[92:95], v[108:111], v[56:59], v[92:95]
    s_cmp_eq_u32 s48, 0
    s_cbranch_scc0 F1_pf1
    buffer_load_dword v3, v4, s[4:7], s24 offen
F1_pf1:
    s_cmp_eq_u32 s48, 1
    s_cbranch_scc0 F1_pf2
    buffer_load_dword v3, v4, s[8:11], s24 offen
F1_pf2:
    s_cmp_eq_u32 s48, 2
    s_cbranch_scc0 F1_pf3
    buffer_load_dword v3, v7, s[16:19], s26 offen
F1_pf3:
    s_waitcnt lgkmcnt(7)
    v_mfma_f32_16x16x32_bf16 v[64:67], v[128:131], v[28:31], v[64:67]
    v_mfma_f32_16x16x32_bf16 v[68:71], v[132:135], v[28:31], v[68:71]
    ds_read_b128 v[44:47], v20 offset:33344
    s_waitcnt lgkmcnt(1)
    v_mfma_f32_16x16x32_bf16 v[92:95], v[156:159], v[28:31], v[92:95]
    v_mfma_f32_16x16x32_bf16 v[72:75], v[136:139], v[28:31], v[72:75]
    ds_read_b128 v[48:51], v20 offset:37952
    v_mfma_f32_16x16x32_bf16 v[76:79], v[140:143], v[28:31], v[76:79]
    v_mfma_f32_16x16x32_bf16 v[92:95], v[156:159], v[32:35], v[92:95]
    ds_read_b128 v[52:55], v20 offset:35904
    v_mfma_f32_16x16x32_bf16 v[80:83], v[144:147], v[28:31], v[80:83]
    v_mfma_f32_16x16x32_bf16 v[84:87], v[148:151], v[28:31], v[84:87]
    ds_read_b128 v[56:59], v20 offset:40512
    v_mfma_f32_16x16x32_bf16 v[88:91], v[152:155], v[28:31], v[88:91]
    v_mfma_f32_16x16x32_bf16 v[92:95], v[128:131], v[36:39], v[92:95]
    v_mfma_f32_16x16x32_bf16 v[64:67], v[128:131], v[32:35], v[64:67]
    v_mfma_f32_16x16x32_bf16 v[68:71], v[132:135], v[32:35], v[68:71]
    v_mfma_f32_16x16x32_bf16 v[72:75], v[136:139], v[32:35], v[72:75]
    v_mfma_f32_16x16x32_bf16 v[76:79], v[140:143], v[32:35], v[76:79]
    v_mfma_f32_16x16x32_bf16 v[80:83], v[144:147], v[32:35], v[80:83]
    v_mfma_f32_16x16x32_bf16 v[84:87], v[148:151], v[32:35], v[84:87]
    v_mfma_f32_16x16x32_bf16 v[88:91], v[152:155], v[32:35], v[88:91]
    v_mfma_f32_16x16x32_bf16 v[92:95], v[128:131], v[40:43], v[92:95]
    s_waitcnt lgkmcnt(3)
    v_mfma_f32_16x16x32_bf16 v[68:71], v[128:131], v[44:47], v[68:71]
    v_mfma_f32_16x16x32_bf16 v[88:91], v[148:151], v[44:47], v[88:91]
    ds_read_b128 v[28:31], v20 offset:33856
    v_mfma_f32_16x16x32_bf16 v[92:95], v[152:155], v[44:47], v[92:95]
    v_mfma_f32_16x16x32_bf16 v[72:75], v[132:135], v[44:47], v[72:75]
    ds_read_b128 v[32:35], v20 offset:38464
    s_waitcnt lgkmcnt(4)
    v_mfma_f32_16x16x32_bf16 v[88:91], v[148:151], v[48:51], v[88:91]
    v_mfma_f32_16x16x32_bf16 v[92:95], v[152:155], v[48:51], v[92:95]
    ds_read_b128 v[36:39], v20 offset:35392
    v_mfma_f32_16x16x32_bf16 v[76:79], v[136:139], v[44:47], v[76:79]
    v_mfma_f32_16x16x32_bf16 v[80:83], v[140:143], v[44:47], v[80:83]
    ds_read_b128 v[40:43], v20 offset:40000
    v_mfma_f32_16x16x32_bf16 v[84:87], v[144:147], v[44:47], v[84:87]
    s_waitcnt lgkmcnt(5)
    v_mfma_f32_16x16x32_bf16 v[88:91], v[128:131], v[52:55], v[88:91]
    ds_write_b128 v16, v[64:67] offset:0
    v_mfma_f32_16x16x32_bf16 v[92:95], v[132:135], v[52:55], v[92:95]
    v_mfma_f32_16x16x32_bf16 v[68:71], v[128:131], v[48:51], v[68:71]
    v_mfma_f32_16x16x32_bf16 v[72:75], v[132:135], v[48:51], v[72:75]
    v_mfma_f32_16x16x32_bf16 v[76:79], v[136:139], v[48:51], v[76:79]
    v_mfma_f32_16x16x32_bf16 v[80:83], v[140:143], v[48:51], v[80:83]
    v_mfma_f32_16x16x32_bf16 v[84:87], v[144:147], v[48:51], v[84:87]
    s_waitcnt lgkmcnt(5)
    v_mfma_f32_16x16x32_bf16 v[88:91], v[128:131], v[56:59], v[88:91]
    v_mfma_f32_16x16x32_bf16 v[92:95], v[132:135], v[56:59], v[92:95]
    s_waitcnt lgkmcnt(4)
    v_mfma_f32_16x16x32_bf16 v[84:87], v[140:143], v[28:31], v[84:87]
    v_mfma_f32_16x16x32_bf16 v[88:91], v[144:147], v[28:31], v[88:91]
    ds_read_b128 v[44:47], v20 offset:34368
    v_mfma_f32_16x16x32_bf16 v[92:95], v[148:151], v[28:31], v[92:95]
    s_waitcnt lgkmcnt(4)
    v_mfma_f32_16x16x32_bf16 v[84:87], v[140:143], v[32:35], v[84:87]
    ds_read_b128 v[48:51], v20 offset:38976
    v_mfma_f32_16x16x32_bf16 v[88:91], v[144:147], v[32:35], v[88:91]
    v_mfma_f32_16x16x32_bf16 v[92:95], v[148:151], v[32:35], v[92:95]
    ds_read_b128 v[52:55], v20 offset:34880
    v_mfma_f32_16x16x32_bf16 v[72:75], v[128:131], v[28:31], v[72:75]
    v_mfma_f32_16x16x32_bf16 v[76:79], v[132:135], v[28:31], v[76:79]
    ds_read_b128 v[56:59], v20 offset:39488
    v_mfma_f32_16x16x32_bf16 v[80:83], v[136:139], v[28:31], v[80:83]
    s_waitcnt lgkmcnt(6)
    v_mfma_f32_16x16x32_bf16 v[84:87], v[128:131], v[36:39], v[84:87]
    ds_write_b128 v16, v[68:71] offset:1024
    v_mfma_f32_16x16x32_bf16 v[88:91], v[132:135], v[36:39], v[88:91]
    v_mfma_f32_16x16x32_bf16 v[92:95], v[136:139], v[36:39], v[92:95]
    v_mfma_f32_16x16x32_bf16 v[72:75], v[128:131], v[32:35], v[72:75]
    v_mfma_f32_16x16x32_bf16 v[76:79], v[132:135], v[32:35], v[76:79]
    v_mfma_f32_16x16x32_bf16 v[80:83], v[136:139], v[32:35], v[80:83]
    s_waitcnt lgkmcnt(6)
    v_mfma_f32_16x16x32_bf16 v[84:87], v[128:131], v[40:43], v[84:87]
    v_mfma_f32_16x16x32_bf16 v[88:91], v[132:135], v[40:43], v[88:91]
    v_mfma_f32_16x16x32_bf16 v[92:95], v[136:139], v[40:43], v[92:95]
    s_waitcnt lgkmcnt(4)
    v_mfma_f32_16x16x32_bf16 v[80:83], v[132:135], v[44:47], v[80:83]
    v_mfma_f32_16x16x32_bf16 v[84:87], v[136:139], v[44:47], v[84:87]
    ds_write_b128 v16, v[72:75] offset:2048
    v_mfma_f32_16x16x32_bf16 v[88:91], v[140:143], v[44:47], v[88:91]
    v_mfma_f32_16x16x32_bf16 v[92:95], v[144:147], v[44:47], v[92:95]
    s_waitcnt lgkmcnt(4)
    v_mfma_f32_16x16x32_bf16 v[80:83], v[132:135], v[48:51], v[80:83]
    v_mfma_f32_16x16x32_bf16 v[84:87], v[136:139], v[48:51], v[84:87]
    v_mfma_f32_16x16x32_bf16 v[88:91], v[140:143], v[48:51], v[88:91]
    v_mfma_f32_16x16x32_bf16 v[92:95], v[144:147], v[48:51], v[92:95]
    v_mfma_f32_16x16x32_bf16 v[76:79], v[128:131], v[44:47], v[76:79]
    s_waitcnt lgkmcnt(3)
    v_mfma_f32_16x16x32_bf16 v[80:83], v[128:131], v[52:55], v[80:83]
    v_mfma_f32_16x16x32_bf16 v[84:87], v[132:135], v[52:55], v[84:87]
    v_mfma_f32_16x16x32_bf16 v[88:91], v[136:139], v[52:55], v[88:91]
    v_mfma_f32_16x16x32_bf16 v[92:95], v[140:143], v[52:55], v[92:95]
    v_mfma_f32_16x16x32_bf16 v[76:79], v[128:131], v[48:51], v[76:79]
    s_waitcnt lgkmcnt(2)
    v_mfma_f32_16x16x32_bf16 v[80:83], v[128:131], v[56:59], v[80:83]
    v_mfma_f32_16x16x32_bf16 v[84:87], v[132:135], v[56:59], v[84:87]
    v_mfma_f32_16x16x32_bf16 v[88:91], v[136:139], v[56:59], v[88:91]
    v_mfma_f32_16x16x32_bf16 v[92:95], v[140:143], v[56:59], v[92:95]
    s_setprio 2
    s_nop 1
    ds_write_b128 v16, v[76:79] offset:3072
    s_nop 0
    ds_write_b128 v16, v[80:83] offset:4096
    ds_write_b128 v16, v[84:87] offset:5120
    ds_write_b128 v16, v[88:91] offset:6144
    ds_write_b128 v16, v[92:95] offset:7168
    s_waitcnt lgkmcnt(0)
    s_barrier
    ds_read_b128 v[64:67], v18 offset:0
    ds_read_b128 v[68:71], v19 offset:0
    ds_read_b128 v[72:75], v18 offset:8192
    ds_read_b128 v[76:79], v19 offset:8192
    ds_read_b128 v[80:83], v18 offset:16384
    ds_read_b128 v[84:87], v19 offset:16384
    ds_read_b128 v[88:91], v18 offset:24576
    ds_read_b128 v[92:95], v19 offset:24576
    s_waitcnt lgkmcnt(0)
    v_add_f32 v64, v64, v72
    v_add_f32 v80, v80, v88
    v_add_f32 v64, v64, v80
    v_add_f32 v65, v65, v73
    v_add_f32 v81, v81, v89
    v_add_f32 v65, v65, v81
    v_add_f32 v66, v66, v74
    v_add_f32 v82, v82, v90
    v_add_f32 v66, v66, v82
    v_add_f32 v67, v67, v75
    v_add_f32 v83, v83, v91
    v_add_f32 v67, v67, v83
    v_add_f32 v68, v68, v76
    v_add_f32 v84, v84, v92
    v_add_f32 v68, v68, v84
    v_add_f32 v69, v69, v77
    v_add_f32 v85, v85, v93
    v_add_f32 v69, v69, v85
    v_add_f32 v70, v70, v78
    v_add_f32 v86, v86, v94
    v_add_f32 v70, v70, v86
    v_add_f32 v71, v71, v79
    v_add_f32 v87, v87, v95
    v_add_f32 v71, v71, v87
    v_cvt_pk_bf16_f32 v20, v64, v65
    v_cvt_pk_bf16_f32 v21, v66, v67
    v_cvt_pk_bf16_f32 v22, v68, v69
    v_cvt_pk_bf16_f32 v23, v70, v71
    buffer_store_dwordx4 v[20:23], v5, s[32:35], s12 offen
F1_end:
    s_endpgm
.globl k3_kernel
.p2align 8
.type k3_kernel,@function
k3_kernel:
    s_cmp_ge_u32 s2, 256
    s_cbranch_scc1 L3_end
    s_load_dwordx2 s[4:5], s[0:1], 144
    s_mov_b32 s6, 268435456
    s_mov_b32 s7, 0x20000
    s_load_dwordx2 s[8:9], s[0:1], 80
    s_mov_b32 s10, 896
    s_mov_b32 s11, 0x20000
    s_load_dwordx2 s[12:13], s[0:1], 128
    s_mov_b32 s14, 1835008
    s_mov_b32 s15, 0x20000
    s_load_dwordx2 s[36:37], s[0:1], 0
    s_mov_b32 s38, 1835008
    s_mov_b32 s39, 0x20000
    s_load_dwordx2 s[40:41], s[0:1], 64
    s_mov_b32 s42, 896
    s_mov_b32 s43, 0x20000
    s_load_dwordx2 s[44:45], s[0:1], 88
    s_mov_b32 s46, 1605632
    s_mov_b32 s47, 0x20000
    s_load_dwordx2 s[48:49], s[0:1], 96
    s_mov_b32 s50, 1605632
    s_mov_b32 s51, 0x20000
    s_load_dwordx2 s[52:53], s[0:1], 104
    s_mov_b32 s54, 1605632
    s_mov_b32 s55, 0x20000
    v_and_b32 v1, 63, v0
    v_lshrrev_b32 v2, 6, v0
    v_lshlrev_b32 v3, 5, v0
    s_mul_i32 s16, s2, 7168
    s_add_u32 s17, s16, 4194304
    v_lshlrev_b32 v5, 4, v1
    v_mov_b32 v88, 0
    v_mov_b32 v89, 0
    v_mov_b32 v90, 0
    v_mov_b32 v91, 0
    v_mov_b32 v92, 0
    v_mov_b32 v93, 0
    v_mov_b32 v94, 0
    v_mov_b32 v95, 0
    v_mov_b32 v96, 0
    v_mov_b32 v97, 0
    v_mov_b32 v98, 0
    v_mov_b32 v99, 0
    v_mov_b32 v100, 0
    v_mov_b32 v101, 0
    v_mov_b32 v102, 0
    v_mov_b32 v103, 0
    v_mov_b32 v104, 0
    v_mov_b32 v105, 0
    v_mov_b32 v106, 0
    v_mov_b32 v107, 0
    v_mov_b32 v108, 0
    v_mov_b32 v109, 0
    v_mov_b32 v110, 0
    v_mov_b32 v111, 0
    v_mov_b32 v112, 0
    v_mov_b32 v113, 0
    v_mov_b32 v114, 0
    v_mov_b32 v115, 0
    v_mov_b32 v116, 0
    v_mov_b32 v117, 0
    v_mov_b32 v118, 0
    v_mov_b32 v119, 0
    v_mov_b32 v120, 0
    v_mov_b32 v121, 0
    v_mov_b32 v122, 0
    v_mov_b32 v123, 0
    v_readfirstlane_b32 s18, v2
    v_mul_u32_u24 v6, 896, v2
    v_add_u32 v6, v6, v5
    v_lshlrev_b32 v7, 3, v2
    s_lshl_b32 s19, s2, 6
    s_add_u32 s19, s19, 65536
    s_mov_b32 s30, 0x05040100
    s_mov_b32 s31, 0x07060302
    v_cmp_gt_u32 vcc, 224, v0
    s_waitcnt lgkmcnt(0)
    s_cmp_ge_u32 s18, 4
    s_cbranch_scc1 L3_cw
    s_and_saveexec_b64 s[20:21], vcc
    buffer_load_dwordx4 v[8:11], v3, s[4:7], s17 offen
    buffer_load_dwordx4 v[12:15], v3, s[4:7], s17 offen offset:16
    s_mov_b64 exec, s[20:21]
    buffer_load_dwordx2 v[124:125], v7, s[4:7], s19 offen
    s_mov_b32 exec_hi, 0x00ffffff
    buffer_load_dwordx4 v[120:123], v6, s[36:39], s16 offen
    s_mov_b32 exec_hi, -1
    v_lshlrev_b32 v3, 2, v0
    s_waitcnt vmcnt(2)
    s_and_saveexec_b64 s[20:21], vcc
    v_perm_b32 v16, v12, v8, s30
    v_perm_b32 v17, v12, v8, s31
    v_perm_b32 v18, v13, v9, s30
    v_perm_b32 v19, v13, v9, s31
    v_perm_b32 v20, v14, v10, s30
    v_perm_b32 v21, v14, v10, s31
    v_perm_b32 v22, v15, v11, s30
    v_perm_b32 v23, v15, v11, s31
    ds_write_b32 v3, v16 offset:0
    ds_write_b32 v3, v17 offset:896
    ds_write_b32 v3, v18 offset:1792
    ds_write_b32 v3, v19 offset:2688
    ds_write_b32 v3, v20 offset:3584
    ds_write_b32 v3, v21 offset:4480
    ds_write_b32 v3, v22 offset:5376
    ds_write_b32 v3, v23 offset:6272
    s_mov_b64 exec, s[20:21]
    s_branch L3_join
L3_cw:
    s_sub_u32 s22, s18, 4
    s_mul_i32 s22, s22, 1792
    s_add_u32 s23, s22, 7168
    s_mov_b32 m0, s23
    s_add_u32 s22, s22, 16384
    s_mov_b32 exec_hi, 0x00ffffff
    s_cmp_eq_u32 s18, 7
    s_cbranch_scc1 L3_cw7
    buffer_load_dwordx4 v5, s[4:7], s22 offen lds
    buffer_load_dwordx4 v5, s[4:7], s22 offen offset:896 lds
    s_branch L3_cw8
L3_cw7:
    buffer_load_dwordx4 v5, s[40:43], 0 offen lds
    s_add_u32 s23, s23, 896
    s_mov_b32 m0, s23
    s_nop 0
    buffer_load_dwordx4 v5, s[8:11], 0 offen lds
L3_cw8:
    buffer_load_dwordx4 v[120:123], v6, s[36:39], s16 offen
    s_mov_b32 exec_hi, -1
    buffer_load_dwordx2 v[124:125], v7, s[4:7], s19 offen
L3_join:
    s_waitcnt vmcnt(0)
L3_join2:
    v_mov_b32 v8, 0
    v_mov_b32 v9, 0
    v_mov_b32 v10, 0
    v_mov_b32 v11, 0
    v_lshlrev_b32 v24, 16, v120
    v_and_b32 v25, 0xffff0000, v120
    v_lshlrev_b32 v26, 16, v121
    v_and_b32 v27, 0xffff0000, v121
    v_lshlrev_b32 v28, 16, v122
    v_and_b32 v29, 0xffff0000, v122
    v_lshlrev_b32 v30, 16, v123
    v_and_b32 v31, 0xffff0000, v123
    v_mov_b32 v126, v125
    v_pk_add_f32 v[32:33], v[24:25], v[124:125] op_sel:[0,0] op_sel_hi:[1,0] neg_lo:[0,1] neg_hi:[0,1]
    v_cvt_pk_bf16_f32 v48, v32, v33
    v_lshlrev_b32 v32, 16, v48
    v_and_b32 v33, 0xffff0000, v48
    v_pk_mul_f32 v[32:33], v[32:33], v[126:127] op_sel:[0,0] op_sel_hi:[1,0]
    v_cvt_pk_bf16_f32 v48, v32, v33
    v_lshlrev_b32 v32, 16, v48
    v_and_b32 v33, 0xffff0000, v48
    v_pk_add_f32 v[34:35], v[26:27], v[124:125] op_sel:[0,0] op_sel_hi:[1,0] neg_lo:[0,1] neg_hi:[0,1]
    v_cvt_pk_bf16_f32 v48, v34, v35
    v_lshlrev_b32 v34, 16, v48
    v_and_b32 v35, 0xffff0000, v48
    v_pk_mul_f32 v[34:35], v[34:35], v[126:127] op_sel:[0,0] op_sel_hi:[1,0]
    v_cvt_pk_bf16_f32 v48, v34, v35
    v_lshlrev_b32 v34, 16, v48
    v_and_b32 v35, 0xffff0000, v48
    v_pk_add_f32 v[36:37], v[28:29], v[124:125] op_sel:[0,0] op_sel_hi:[1,0] neg_lo:[0,1] neg_hi:[0,1]
    v_cvt_pk_bf16_f32 v48, v36, v37
    v_lshlrev_b32 v36, 16, v48
    v_and_b32 v37, 0xffff0000, v48
    v_pk_mul_f32 v[36:37], v[36:37], v[126:127] op_sel:[0,0] op_sel_hi:[1,0]
    v_cvt_pk_bf16_f32 v48, v36, v37
    v_lshlrev_b32 v36, 16, v48
    v_and_b32 v37, 0xffff0000, v48
    v_pk_add_f32 v[38:39], v[30:31], v[124:125] op_sel:[0,0] op_sel_hi:[1,0] neg_lo:[0,1] neg_hi:[0,1]
    v_cvt_pk_bf16_f32 v48, v38, v39
    v_lshlrev_b32 v38, 16, v48
    v_and_b32 v39, 0xffff0000, v48
    v_pk_mul_f32 v[38:39], v[38:39], v[126:127] op_sel:[0,0] op_sel_hi:[1,0]
    v_cvt_pk_bf16_f32 v48, v38, v39
    v_lshlrev_b32 v38, 16, v48
    v_and_b32 v39, 0xffff0000, v48
    s_waitcnt lgkmcnt(0)
    s_barrier
    s_mov_b32 exec_hi, 0x00ffffff
    ds_read_b128 v[92:95], v5 offset:8064
    ds_read_b128 v[88:91], v5 offset:7168
    ds_read_b128 v[112:115], v5 offset:12544
    ds_read_b128 v[8:11], v6
    ds_read_b128 v[96:99], v5 offset:8960
    ds_read_b128 v[104:107], v5 offset:10752
    ds_read_b128 v[100:103], v5 offset:9856
    ds_read_b128 v[116:119], v5 offset:13440
    ds_read_b128 v[108:111], v5 offset:11648
    s_mov_b32 exec_hi, -1
    s_waitcnt lgkmcnt(6)
    v_lshlrev_b32 v64, 16, v92
    v_and_b32 v65, 0xffff0000, v92
    v_lshlrev_b32 v66, 16, v93
    v_and_b32 v67, 0xffff0000, v93
    v_lshlrev_b32 v68, 16, v94
    v_and_b32 v69, 0xffff0000, v94
    v_lshlrev_b32 v70, 16, v95
    v_and_b32 v71, 0xffff0000, v95
    v_lshlrev_b32 v72, 16, v88
    v_and_b32 v73, 0xffff0000, v88
    v_lshlrev_b32 v74, 16, v89
    v_and_b32 v75, 0xffff0000, v89
    v_lshlrev_b32 v76, 16, v90
    v_and_b32 v77, 0xffff0000, v90
    v_lshlrev_b32 v78, 16, v91
    v_and_b32 v79, 0xffff0000, v91
    v_lshlrev_b32 v80, 16, v112
    v_and_b32 v81, 0xffff0000, v112
    v_lshlrev_b32 v82, 16, v113
    v_and_b32 v83, 0xffff0000, v113
    v_lshlrev_b32 v84, 16, v114
    v_and_b32 v85, 0xffff0000, v114
    v_lshlrev_b32 v86, 16, v115
    v_and_b32 v87, 0xffff0000, v115
    v_pk_mul_f32 v[32:33], v[32:33], v[64:65]
    v_cvt_pk_bf16_f32 v48, v32, v33
    v_lshlrev_b32 v32, 16, v48
    v_and_b32 v33, 0xffff0000, v48
    v_pk_add_f32 v[32:33], v[32:33], v[72:73]
    v_cvt_pk_bf16_f32 v48, v32, v33
    v_lshlrev_b32 v32, 16, v48
    v_and_b32 v33, 0xffff0000, v48
    v_pk_mul_f32 v[32:33], v[32:33], v[80:81]
    v_cvt_pk_bf16_f32 v48, v32, v33
    v_lshlrev_b32 v32, 16, v48
    v_and_b32 v33, 0xffff0000, v48
    v_pk_mul_f32 v[34:35], v[34:35], v[66:67]
    v_cvt_pk_bf16_f32 v48, v34, v35
    v_lshlrev_b32 v34, 16, v48
    v_and_b32 v35, 0xffff0000, v48
    v_pk_add_f32 v[34:35], v[34:35], v[74:75]
    v_cvt_pk_bf16_f32 v48, v34, v35
    v_lshlrev_b32 v34, 16, v48
    v_and_b32 v35, 0xffff0000, v48
    v_pk_mul_f32 v[34:35], v[34:35], v[82:83]
    v_cvt_pk_bf16_f32 v48, v34, v35
    v_lshlrev_b32 v34, 16, v48
    v_and_b32 v35, 0xffff0000, v48
    v_pk_mul_f32 v[36:37], v[36:37], v[68:69]
    v_cvt_pk_bf16_f32 v48, v36, v37
    v_lshlrev_b32 v36, 16, v48
    v_and_b32 v37, 0xffff0000, v48
    v_pk_add_f32 v[36:37], v[36:37], v[76:77]
    v_cvt_pk_bf16_f32 v48, v36, v37
    v_lshlrev_b32 v36, 16, v48
    v_and_b32 v37, 0xffff0000, v48
    v_pk_mul_f32 v[36:37], v[36:37], v[84:85]
    v_cvt_pk_bf16_f32 v48, v36, v37
    v_lshlrev_b32 v36, 16, v48
    v_and_b32 v37, 0xffff0000, v48
    v_pk_mul_f32 v[38:39], v[38:39], v[70:71]
    v_cvt_pk_bf16_f32 v48, v38, v39
    v_lshlrev_b32 v38, 16, v48
    v_and_b32 v39, 0xffff0000, v48
    v_pk_add_f32 v[38:39], v[38:39], v[78:79]
    v_cvt_pk_bf16_f32 v48, v38, v39
    v_lshlrev_b32 v38, 16, v48
    v_and_b32 v39, 0xffff0000, v48
    v_pk_mul_f32 v[38:39], v[38:39], v[86:87]
    v_cvt_pk_bf16_f32 v48, v38, v39
    v_lshlrev_b32 v38, 16, v48
    v_and_b32 v39, 0xffff0000, v48
    s_waitcnt lgkmcnt(4)
    v_lshlrev_b32 v16, 16, v8
    v_and_b32 v17, 0xffff0000, v8
    v_lshlrev_b32 v18, 16, v9
    v_and_b32 v19, 0xffff0000, v9
    v_lshlrev_b32 v20, 16, v10
    v_and_b32 v21, 0xffff0000, v10
    v_lshlrev_b32 v22, 16, v11
    v_and_b32 v23, 0xffff0000, v11
    v_lshlrev_b32 v64, 16, v96
    v_and_b32 v65, 0xffff0000, v96
    v_lshlrev_b32 v66, 16, v97
    v_and_b32 v67, 0xffff0000, v97
    v_lshlrev_b32 v68, 16, v98
    v_and_b32 v69, 0xffff0000, v98
    v_lshlrev_b32 v70, 16, v99
    v_and_b32 v71, 0xffff0000, v99
    v_pk_add_f32 v[16:17], v[16:17], v[32:33]
    v_cvt_pk_bf16_f32 v48, v16, v17
    v_lshlrev_b32 v16, 16, v48
    v_and_b32 v17, 0xffff0000, v48
    v_pk_mul_f32 v[16:17], v[16:17], v[64:65]
    v_cvt_pk_bf16_f32 v48, v16, v17
    v_lshlrev_b32 v16, 16, v48
    v_and_b32 v17, 0xffff0000, v48
    v_pk_add_f32 v[16:17], v[16:17], v[24:25]
    v_cvt_pk_bf16_f32 v8, v16, v17
    v_lshlrev_b32 v16, 16, v8
    v_and_b32 v17, 0xffff0000, v8
    v_pk_add_f32 v[18:19], v[18:19], v[34:35]
    v_cvt_pk_bf16_f32 v48, v18, v19
    v_lshlrev_b32 v18, 16, v48
    v_and_b32 v19, 0xffff0000, v48
    v_pk_mul_f32 v[18:19], v[18:19], v[66:67]
    v_cvt_pk_bf16_f32 v48, v18, v19
    v_lshlrev_b32 v18, 16, v48
    v_and_b32 v19, 0xffff0000, v48
    v_pk_add_f32 v[18:19], v[18:19], v[26:27]
    v_cvt_pk_bf16_f32 v9, v18, v19
    v_lshlrev_b32 v18, 16, v9
    v_and_b32 v19, 0xffff0000, v9
    v_pk_add_f32 v[20:21], v[20:21], v[36:37]
    v_cvt_pk_bf16_f32 v48, v20, v21
    v_lshlrev_b32 v20, 16, v48
    v_and_b32 v21, 0xffff0000, v48
    v_pk_mul_f32 v[20:21], v[20:21], v[68:69]
    v_cvt_pk_bf16_f32 v48, v20, v21
    v_lshlrev_b32 v20, 16, v48
    v_and_b32 v21, 0xffff0000, v48
    v_pk_add_f32 v[20:21], v[20:21], v[28:29]
    v_cvt_pk_bf16_f32 v10, v20, v21
    v_lshlrev_b32 v20, 16, v10
    v_and_b32 v21, 0xffff0000, v10
    v_pk_add_f32 v[22:23], v[22:23], v[38:39]
    v_cvt_pk_bf16_f32 v48, v22, v23
    v_lshlrev_b32 v22, 16, v48
    v_and_b32 v23, 0xffff0000, v48
    v_pk_mul_f32 v[22:23], v[22:23], v[70:71]
    v_cvt_pk_bf16_f32 v48, v22, v23
    v_lshlrev_b32 v22, 16, v48
    v_and_b32 v23, 0xffff0000, v48
    v_pk_add_f32 v[22:23], v[22:23], v[30:31]
    v_cvt_pk_bf16_f32 v11, v22, v23
    v_lshlrev_b32 v22, 16, v11
    v_and_b32 v23, 0xffff0000, v11
    v_add_u32 v6, s16, v6
    s_mov_b32 s17, 2097152
    s_mov_b32 exec_hi, 0x00ffffff
    buffer_store_dwordx4 v[8:11], v6, s[4:7], s17 offen sc1
    s_mov_b32 exec_hi, -1
    v_pk_add_f32 v[40:41], v[16:17], v[18:19]
    v_pk_add_f32 v[42:43], v[20:21], v[22:23]
    v_pk_add_f32 v[40:41], v[40:41], v[42:43]
    v_add_f32 v32, v40, v41
    s_nop 1
    v_add_f32_dpp v32, v32, v32 row_shr:1 row_mask:0xf bank_mask:0xf bound_ctrl:0
    s_nop 1
    v_add_f32_dpp v32, v32, v32 row_shr:2 row_mask:0xf bank_mask:0xf bound_ctrl:0
    s_nop 1
    v_add_f32_dpp v32, v32, v32 row_shr:4 row_mask:0xf bank_mask:0xf bound_ctrl:0
    s_nop 1
    v_add_f32_dpp v32, v32, v32 row_shr:8 row_mask:0xf bank_mask:0xf bound_ctrl:0
    s_nop 1
    v_add_f32_dpp v32, v32, v32 row_bcast:15 row_mask:0xa bank_mask:0xf
    s_nop 1
    v_add_f32_dpp v32, v32, v32 row_bcast:31 row_mask:0xc bank_mask:0xf
    s_nop 0
    v_readlane_b32 s28, v32, 63
    v_mov_b32 v44, 0x3b124925
    s_nop 0
    v_mul_f32 v34, s28, v44
    v_mov_b32 v32, 0
    s_mov_b32 exec_hi, 0x00ffffff
    v_pk_add_f32 v[40:41], v[16:17], v[34:35] op_sel:[0,0] op_sel_hi:[1,0] neg_lo:[0,1] neg_hi:[0,1]
    v_pk_add_f32 v[42:43], v[18:19], v[34:35] op_sel:[0,0] op_sel_hi:[1,0] neg_lo:[0,1] neg_hi:[0,1]
    v_pk_mul_f32 v[36:37], v[40:41], v[40:41]
    v_pk_fma_f32 v[36:37], v[42:43], v[42:43], v[36:37]
    v_pk_add_f32 v[40:41], v[20:21], v[34:35] op_sel:[0,0] op_sel_hi:[1,0] neg_lo:[0,1] neg_hi:[0,1]
    v_pk_add_f32 v[42:43], v[22:23], v[34:35] op_sel:[0,0] op_sel_hi:[1,0] neg_lo:[0,1] neg_hi:[0,1]
    v_pk_fma_f32 v[36:37], v[40:41], v[40:41], v[36:37]
    v_pk_fma_f32 v[36:37], v[42:43], v[42:43], v[36:37]
    v_add_f32 v32, v36, v37
    s_mov_b32 exec_hi, -1
    s_nop 0
    v_add_f32_dpp v32, v32, v32 row_shr:1 row_mask:0xf bank_mask:0xf bound_ctrl:0
    s_nop 1
    v_add_f32_dpp v32, v32, v32 row_shr:2 row_mask:0xf bank_mask:0xf bound_ctrl:0
    s_nop 1
    v_add_f32_dpp v32, v32, v32 row_shr:4 row_mask:0xf bank_mask:0xf bound_ctrl:0
    s_nop 1
    v_add_f32_dpp v32, v32, v32 row_shr:8 row_mask:0xf bank_mask:0xf bound_ctrl:0
    s_nop 1
    v_add_f32_dpp v32, v32, v32 row_bcast:15 row_mask:0xa bank_mask:0xf
    s_nop 1
    v_add_f32_dpp v32, v32, v32 row_bcast:31 row_mask:0xc bank_mask:0xf
    s_nop 0
    v_readlane_b32 s28, v32, 63
    s_nop 1
    v_mul_f32 v36, s28, v44
    v_cvt_pk_bf16_f32 v40, v34, v36
    v_lshlrev_b32 v34, 16, v40
    v_and_b32 v36, 0xffff0000, v40
    v_add_f32 v36, 0x3727c5ac, v36
    v_cvt_pk_bf16_f32 v40, v36, v36
    v_lshlrev_b32 v36, 16, v40
    v_sqrt_f32 v36, v36
    s_nop 0
    v_cvt_pk_bf16_f32 v40, v36, v36
    v_lshlrev_b32 v36, 16, v40
    v_rcp_f32 v38, v36
    v_pk_add_f32 v[48:49], v[16:17], v[34:35] op_sel:[0,0] op_sel_hi:[1,0] neg_lo:[0,1] neg_hi:[0,1]
    v_cvt_pk_bf16_f32 v46, v48, v49
    v_lshlrev_b32 v48, 16, v46
    v_and_b32 v49, 0xffff0000, v46
    v_pk_mul_f32 v[48:49], v[48:49], v[38:39] op_sel:[0,0] op_sel_hi:[1,0]
    v_cvt_pk_bf16_f32 v46, v48, v49
    v_lshlrev_b32 v48, 16, v46
    v_and_b32 v49, 0xffff0000, v46
    v_pk_add_f32 v[50:51], v[18:19], v[34:35] op_sel:[0,0] op_sel_hi:[1,0] neg_lo:[0,1] neg_hi:[0,1]
    v_cvt_pk_bf16_f32 v46, v50, v51
    v_lshlrev_b32 v50, 16, v46
    v_and_b32 v51, 0xffff0000, v46
    v_pk_mul_f32 v[50:51], v[50:51], v[38:39] op_sel:[0,0] op_sel_hi:[1,0]
    v_cvt_pk_bf16_f32 v46, v50, v51
    v_lshlrev_b32 v50, 16, v46
    v_and_b32 v51, 0xffff0000, v46
    v_pk_add_f32 v[52:53], v[20:21], v[34:35] op_sel:[0,0] op_sel_hi:[1,0] neg_lo:[0,1] neg_hi:[0,1]
    v_cvt_pk_bf16_f32 v46, v52, v53
    v_lshlrev_b32 v52, 16, v46
    v_and_b32 v53, 0xffff0000, v46
    v_pk_mul_f32 v[52:53], v[52:53], v[38:39] op_sel:[0,0] op_sel_hi:[1,0]
    v_cvt_pk_bf16_f32 v46, v52, v53
    v_lshlrev_b32 v52, 16, v46
    v_and_b32 v53, 0xffff0000, v46
    v_pk_add_f32 v[54:55], v[22:23], v[34:35] op_sel:[0,0] op_sel_hi:[1,0] neg_lo:[0,1] neg_hi:[0,1]
    v_cvt_pk_bf16_f32 v46, v54, v55
    v_lshlrev_b32 v54, 16, v46
    v_and_b32 v55, 0xffff0000, v46
    v_pk_mul_f32 v[54:55], v[54:55], v[38:39] op_sel:[0,0] op_sel_hi:[1,0]
    v_cvt_pk_bf16_f32 v46, v54, v55
    v_lshlrev_b32 v54, 16, v46
    v_and_b32 v55, 0xffff0000, v46
    s_waitcnt lgkmcnt(0)
    v_lshlrev_b32 v64, 16, v104
    v_and_b32 v65, 0xffff0000, v104
    v_lshlrev_b32 v66, 16, v105
    v_and_b32 v67, 0xffff0000, v105
    v_lshlrev_b32 v68, 16, v106
    v_and_b32 v69, 0xffff0000, v106
    v_lshlrev_b32 v70, 16, v107
    v_and_b32 v71, 0xffff0000, v107
    v_lshlrev_b32 v72, 16, v100
    v_and_b32 v73, 0xffff0000, v100
    v_lshlrev_b32 v74, 16, v101
    v_and_b32 v75, 0xffff0000, v101
    v_lshlrev_b32 v76, 16, v102
    v_and_b32 v77, 0xffff0000, v102
    v_lshlrev_b32 v78, 16, v103
    v_and_b32 v79, 0xffff0000, v103
    v_lshlrev_b32 v80, 16, v116
    v_and_b32 v81, 0xffff0000, v116
    v_lshlrev_b32 v82, 16, v117
    v_and_b32 v83, 0xffff0000, v117
    v_lshlrev_b32 v84, 16, v118
    v_and_b32 v85, 0xffff0000, v118
    v_lshlrev_b32 v86, 16, v119
    v_and_b32 v87, 0xffff0000, v119
    v_pk_mul_f32 v[48:49], v[48:49], v[64:65]
    v_cvt_pk_bf16_f32 v46, v48, v49
    v_lshlrev_b32 v48, 16, v46
    v_and_b32 v49, 0xffff0000, v46
    v_pk_add_f32 v[48:49], v[48:49], v[72:73]
    v_cvt_pk_bf16_f32 v24, v48, v49
    v_lshlrev_b32 v48, 16, v24
    v_and_b32 v49, 0xffff0000, v24
    v_pk_mul_f32 v[32:33], v[48:49], v[80:81]
    v_pk_mul_f32 v[50:51], v[50:51], v[66:67]
    v_cvt_pk_bf16_f32 v46, v50, v51
    v_lshlrev_b32 v50, 16, v46
    v_and_b32 v51, 0xffff0000, v46
    v_pk_add_f32 v[50:51], v[50:51], v[74:75]
    v_cvt_pk_bf16_f32 v25, v50, v51
    v_lshlrev_b32 v50, 16, v25
    v_and_b32 v51, 0xffff0000, v25
    v_pk_fma_f32 v[32:33], v[50:51], v[82:83], v[32:33]
    v_pk_mul_f32 v[52:53], v[52:53], v[68:69]
    v_cvt_pk_bf16_f32 v46, v52, v53
    v_lshlrev_b32 v52, 16, v46
    v_and_b32 v53, 0xffff0000, v46
    v_pk_add_f32 v[52:53], v[52:53], v[76:77]
    v_cvt_pk_bf16_f32 v26, v52, v53
    v_lshlrev_b32 v52, 16, v26
    v_and_b32 v53, 0xffff0000, v26
    v_pk_fma_f32 v[32:33], v[52:53], v[84:85], v[32:33]
    v_pk_mul_f32 v[54:55], v[54:55], v[70:71]
    v_cvt_pk_bf16_f32 v46, v54, v55
    v_lshlrev_b32 v54, 16, v46
    v_and_b32 v55, 0xffff0000, v46
    v_pk_add_f32 v[54:55], v[54:55], v[78:79]
    v_cvt_pk_bf16_f32 v27, v54, v55
    v_lshlrev_b32 v54, 16, v27
    v_and_b32 v55, 0xffff0000, v27
    v_pk_fma_f32 v[32:33], v[54:55], v[86:87], v[32:33]
    v_add_f32 v32, v32, v33
    s_mov_b32 s17, 6291456
    s_mov_b32 exec_hi, 0x00ffffff
    buffer_store_dwordx4 v[24:27], v6, s[4:7], s17 offen sc1
    s_mov_b32 exec_hi, -1
    v_lshlrev_b32 v64, 16, v108
    v_and_b32 v65, 0xffff0000, v108
    v_lshlrev_b32 v66, 16, v109
    v_and_b32 v67, 0xffff0000, v109
    v_lshlrev_b32 v68, 16, v110
    v_and_b32 v69, 0xffff0000, v110
    v_lshlrev_b32 v70, 16, v111
    v_and_b32 v71, 0xffff0000, v111
    v_add_f32_dpp v32, v32, v32 row_shr:1 row_mask:0xf bank_mask:0xf bound_ctrl:0
    s_nop 1
    v_add_f32_dpp v32, v32, v32 row_shr:2 row_mask:0xf bank_mask:0xf bound_ctrl:0
    s_nop 1
    v_add_f32_dpp v32, v32, v32 row_shr:4 row_mask:0xf bank_mask:0xf bound_ctrl:0
    s_nop 1
    v_add_f32_dpp v32, v32, v32 row_shr:8 row_mask:0xf bank_mask:0xf bound_ctrl:0
    s_nop 1
    v_add_f32_dpp v32, v32, v32 row_bcast:15 row_mask:0xa bank_mask:0xf
    s_nop 1
    v_add_f32_dpp v32, v32, v32 row_bcast:31 row_mask:0xc bank_mask:0xf
    v_pk_mul_f32 v[48:49], v[48:49], v[64:65]
    v_cvt_pk_bf16_f32 v46, v48, v49
    v_lshlrev_b32 v48, 16, v46
    v_and_b32 v49, 0xffff0000, v46
    v_pk_add_f32 v[48:49], v[48:49], v[16:17]
    v_cvt_pk_bf16_f32 v28, v48, v49
    v_pk_mul_f32 v[50:51], v[50:51], v[66:67]
    v_cvt_pk_bf16_f32 v46, v50, v51
    v_lshlrev_b32 v50, 16, v46
    v_and_b32 v51, 0xffff0000, v46
    v_pk_add_f32 v[50:51], v[50:51], v[18:19]
    v_cvt_pk_bf16_f32 v29, v50, v51
    v_pk_mul_f32 v[52:53], v[52:53], v[68:69]
    v_cvt_pk_bf16_f32 v46, v52, v53
    v_lshlrev_b32 v52, 16, v46
    v_and_b32 v53, 0xffff0000, v46
    v_pk_add_f32 v[52:53], v[52:53], v[20:21]
    v_cvt_pk_bf16_f32 v30, v52, v53
    v_pk_mul_f32 v[54:55], v[54:55], v[70:71]
    v_cvt_pk_bf16_f32 v46, v54, v55
    v_lshlrev_b32 v54, 16, v46
    v_and_b32 v55, 0xffff0000, v46
    v_pk_add_f32 v[54:55], v[54:55], v[22:23]
    v_cvt_pk_bf16_f32 v31, v54, v55
    v_cvt_pk_bf16_f32 v34, v32, v32
    s_lshl_b32 s16, s2, 3
    v_add_u32 v35, s16, v2
    v_and_b32 v36, 0xffff, v34
    v_bfe_i32 v37, v36, 15, 1
    v_or_b32 v37, 0x8000, v37
    v_xor_b32 v36, v36, v37
    v_sub_u32 v38, 2047, v35
    v_lshl_or_b32 v40, v36, 16, v38
    v_lshlrev_b32 v35, 2, v35
    s_mov_b32 exec_hi, 0x00ffffff
    buffer_store_dwordx4 v[28:31], v6, s[12:15], 0 offen sc1
    s_mov_b32 exec_lo, 0
    s_mov_b32 exec_hi, 0x80000000
    s_mov_b32 s17, 8388608
    buffer_store_dword v40, v35, s[4:7], s17 offen
L3_end:
    s_endpgm
.globl k4_kernel
.p2align 8
.type k4_kernel,@function
k4_kernel:
    s_cmp_ge_u32 s2, 224
    s_cbranch_scc1 L4_end
    s_load_dwordx2 s[4:5], s[0:1], 144
    s_mov_b32 s6, 268435456
    s_mov_b32 s7, 0x20000
    s_load_dwordx2 s[8:9], s[0:1], 88
    s_mov_b32 s10, 1605632
    s_mov_b32 s11, 0x20000
    s_load_dwordx2 s[12:13], s[0:1], 96
    s_mov_b32 s14, 1605632
    s_mov_b32 s15, 0x20000
    s_load_dwordx2 s[48:49], s[0:1], 104
    s_mov_b32 s50, 1605632
    s_mov_b32 s51, 0x20000
    s_mov_b32 s30, 0x3fb8aa3b
    s_mov_b32 s31, 0x32a57060
    s_mov_b32 s32, 0x3f317218
    v_and_b32 v1, 63, v0
    v_lshrrev_b32 v2, 6, v0
    s_and_b32 s16, s2, 7
    s_mul_i32 s16, s16, 28
    s_lshr_b32 s17, s2, 3
    s_add_u32 s16, s16, s17
    s_lshl_b32 s17, s16, 4
    v_lshrrev_b32 v3, 1, v1
    v_lshl_add_u32 v3, v2, 5, v3
    v_mul_u32_u24 v3, 3584, v3
    v_add_u32 v3, s17, v3
    v_readfirstlane_b32 s18, v2
    v_lshlrev_b32 v4, 5, v0
    v_lshlrev_b32 v10, 4, v0
    s_mov_b32 s19, 8388608
    s_mul_i32 s33, s16, 7168
    s_waitcnt lgkmcnt(0)
    s_cmp_ge_u32 s18, 4
    s_cbranch_scc0 L4_cmp
    s_sub_u32 s18, s18, 4
    v_subrev_u32 v3, 458752, v3
    v_subrev_u32 v10, 4096, v10
    s_lshl_b32 s22, s18, 10
    s_mov_b32 s24, 0x55555555
    s_mov_b32 s25, 0x55555555
    s_mov_b32 s26, 0xaaaaaaaa
    s_mov_b32 s27, 0xaaaaaaaa
    s_add_u32 s23, s22, 0
    s_mov_b32 m0, s23
    s_mov_b32 s28, 0
    s_mov_b64 exec, s[24:25]
    buffer_load_dwordx4 v3, s[8:11], s28 offen lds
    s_mov_b64 exec, s[26:27]
    buffer_load_dwordx4 v3, s[12:15], s28 offen lds
    s_add_u32 s23, s22, 4096
    s_mov_b32 m0, s23
    s_mov_b32 s28, 458752
    s_mov_b64 exec, s[24:25]
    buffer_load_dwordx4 v3, s[8:11], s28 offen lds
    s_mov_b64 exec, s[26:27]
    buffer_load_dwordx4 v3, s[12:15], s28 offen lds
    s_add_u32 s23, s22, 8192
    s_mov_b32 m0, s23
    s_mov_b32 s28, 917504
    s_mov_b64 exec, s[24:25]
    buffer_load_dwordx4 v3, s[8:11], s28 offen lds
    s_mov_b64 exec, s[26:27]
    buffer_load_dwordx4 v3, s[12:15], s28 offen lds
    s_mov_b64 exec, -1
    s_cmp_ge_u32 s18, 2
    s_cbranch_scc1 L4_alt
    s_add_u32 s23, s22, 12288
    s_mov_b32 m0, s23
    s_mov_b32 s28, 1376256
    s_mov_b64 exec, s[24:25]
    buffer_load_dwordx4 v3, s[8:11], s28 offen lds
    s_mov_b64 exec, s[26:27]
    buffer_load_dwordx4 v3, s[12:15], s28 offen lds
    s_mov_b64 exec, -1
    s_add_u32 s23, s22, 14336
    s_mov_b32 m0, s23
    s_nop 0
    buffer_load_dwordx4 v10, s[48:51], s33 offen lds
    s_branch L4_dmadone
L4_alt:
    s_add_u32 s23, s22, 14336
    s_mov_b32 m0, s23
    s_nop 0
    buffer_load_dwordx4 v10, s[48:51], s33 offen lds
    buffer_load_dwordx4 v10, s[48:51], s33 offen offset:2048 lds
    s_cmp_eq_u32 s18, 2
    s_cselect_b32 s28, 2048, 0
    s_add_u32 s23, s23, s28
    s_mov_b32 m0, s23
    s_add_u32 s28, s28, s33
    buffer_load_dwordx4 v10, s[48:51], s28 offen offset:2048 lds
L4_dmadone:
    s_barrier
    s_waitcnt vmcnt(0)
    s_barrier
    s_endpgm
L4_cmp:
    buffer_load_dwordx4 v[16:19], v4, s[4:7], s19 offen
    buffer_load_dwordx4 v[20:23], v4, s[4:7], s19 offen offset:16
    s_waitcnt vmcnt(0)
    v_max_u32 v24, v16, v17
    v_min_u32 v17, v16, v17
    v_max_u32 v16, v18, v19
    v_min_u32 v19, v18, v19
    v_max_u32 v18, v20, v21
    v_min_u32 v21, v20, v21
    v_max_u32 v20, v22, v23
    v_min_u32 v23, v22, v23
    v_max_u32 v22, v24, v16
    v_min_u32 v16, v24, v16
    v_max_u32 v24, v17, v19
    v_min_u32 v19, v17, v19
    v_max_u32 v17, v18, v20
    v_min_u32 v20, v18, v20
    v_max_u32 v18, v21, v23
    v_min_u32 v23, v21, v23
    v_max_u32 v21, v24, v16
    v_min_u32 v16, v24, v16
    v_max_u32 v24, v18, v20
    v_min_u32 v20, v18, v20
    v_max_u32 v18, v22, v17
    v_min_u32 v17, v22, v17
    v_max_u32 v22, v19, v23
    v_min_u32 v23, v19, v23
    v_max_u32 v19, v21, v24
    v_min_u32 v24, v21, v24
    v_max_u32 v21, v16, v20
    v_min_u32 v20, v16, v20
    v_max_u32 v16, v19, v17
    v_min_u32 v17, v19, v17
    v_max_u32 v19, v22, v20
    v_min_u32 v20, v22, v20
    v_max_u32 v22, v21, v17
    v_min_u32 v17, v21, v17
    v_max_u32 v21, v19, v24
    v_min_u32 v24, v19, v24
    v_max_u32 v19, v21, v17
    v_min_u32 v17, v21, v17
    v_max_u32_dpp v25, v18, v18 row_shr:1 row_mask:0xf bank_mask:0xf bound_ctrl:0
    s_nop 1
    v_max_u32_dpp v25, v25, v25 row_shr:2 row_mask:0xf bank_mask:0xf bound_ctrl:0
    s_nop 1
    v_max_u32_dpp v25, v25, v25 row_shr:4 row_mask:0xf bank_mask:0xf bound_ctrl:0
    s_nop 1
    v_max_u32_dpp v25, v25, v25 row_shr:8 row_mask:0xf bank_mask:0xf bound_ctrl:0
    s_nop 1
    v_max_u32_dpp v25, v25, v25 row_bcast:15 row_mask:0xa bank_mask:0xf
    s_nop 1
    v_max_u32_dpp v25, v25, v25 row_bcast:31 row_mask:0xc bank_mask:0xf
    s_nop 0
    v_readlane_b32 s40, v25, 63
    s_nop 1
    v_cmp_eq_u32_e64 s[20:21], s40, v18
    s_nop 1
    v_cndmask_b32_e64 v18, v18, v16, s[20:21]
    v_cndmask_b32_e64 v16, v16, v22, s[20:21]
    v_cndmask_b32_e64 v22, v22, v19, s[20:21]
    v_max_u32_dpp v25, v18, v18 row_shr:1 row_mask:0xf bank_mask:0xf bound_ctrl:0
    v_cndmask_b32_e64 v19, v19, v17, s[20:21]
    v_cndmask_b32_e64 v17, v17, v24, s[20:21]
    v_max_u32_dpp v25, v25, v25 row_shr:2 row_mask:0xf bank_mask:0xf bound_ctrl:0
    v_cndmask_b32_e64 v24, v24, v20, s[20:21]
    v_cndmask_b32_e64 v20, v20, v23, s[20:21]
    v_max_u32_dpp v25, v25, v25 row_shr:4 row_mask:0xf bank_mask:0xf bound_ctrl:0
    s_nop 1
    v_max_u32_dpp v25, v25, v25 row_shr:8 row_mask:0xf bank_mask:0xf bound_ctrl:0
    s_nop 1
    v_max_u32_dpp v25, v25, v25 row_bcast:15 row_mask:0xa bank_mask:0xf
    s_nop 1
    v_max_u32_dpp v25, v25, v25 row_bcast:31 row_mask:0xc bank_mask:0xf
    s_nop 0
    v_readlane_b32 s41, v25, 63
    s_nop 1
    v_cmp_eq_u32_e64 s[20:21], s41, v18
    s_nop 1
    v_cndmask_b32_e64 v18, v18, v16, s[20:21]
    v_cndmask_b32_e64 v16, v16, v22, s[20:21]
    v_cndmask_b32_e64 v22, v22, v19, s[20:21]
    v_max_u32_dpp v25, v18, v18 row_shr:1 row_mask:0xf bank_mask:0xf bound_ctrl:0
    v_cndmask_b32_e64 v19, v19, v17, s[20:21]
    v_cndmask_b32_e64 v17, v17, v24, s[20:21]
    v_max_u32_dpp v25, v25, v25 row_shr:2 row_mask:0xf bank_mask:0xf bound_ctrl:0
    v_cndmask_b32_e64 v24, v24, v20, s[20:21]
    s_nop 0
    v_max_u32_dpp v25, v25, v25 row_shr:4 row_mask:0xf bank_mask:0xf bound_ctrl:0
    s_nop 1
    v_max_u32_dpp v25, v25, v25 row_shr:8 row_mask:0xf bank_mask:0xf bound_ctrl:0
    s_nop 1
    v_max_u32_dpp v25, v25, v25 row_bcast:15 row_mask:0xa bank_mask:0xf
    s_nop 1
    v_max_u32_dpp v25, v25, v25 row_bcast:31 row_mask:0xc bank_mask:0xf
    s_nop 0
    v_readlane_b32 s42, v25, 63
    s_nop 1
    v_cmp_eq_u32_e64 s[20:21], s42, v18
    s_nop 1
    v_cndmask_b32_e64 v18, v18, v16, s[20:21]
    v_cndmask_b32_e64 v16, v16, v22, s[20:21]
    v_cndmask_b32_e64 v22, v22, v19, s[20:21]
    v_max_u32_dpp v25, v18, v18 row_shr:1 row_mask:0xf bank_mask:0xf bound_ctrl:0
    v_cndmask_b32_e64 v19, v19, v17, s[20:21]
    v_cndmask_b32_e64 v17, v17, v24, s[20:21]
    v_max_u32_dpp v25, v25, v25 row_shr:2 row_mask:0xf bank_mask:0xf bound_ctrl:0
    s_nop 1
    v_max_u32_dpp v25, v25, v25 row_shr:4 row_mask:0xf bank_mask:0xf bound_ctrl:0
    s_nop 1
    v_max_u32_dpp v25, v25, v25 row_shr:8 row_mask:0xf bank_mask:0xf bound_ctrl:0
    s_nop 1
    v_max_u32_dpp v25, v25, v25 row_bcast:15 row_mask:0xa bank_mask:0xf
    s_nop 1
    v_max_u32_dpp v25, v25, v25 row_bcast:31 row_mask:0xc bank_mask:0xf
    s_nop 0
    v_readlane_b32 s43, v25, 63
    s_nop 1
    v_cmp_eq_u32_e64 s[20:21], s43, v18
    s_nop 1
    v_cndmask_b32_e64 v18, v18, v16, s[20:21]
    v_cndmask_b32_e64 v16, v16, v22, s[20:21]
    v_cndmask_b32_e64 v22, v22, v19, s[20:21]
    v_max_u32_dpp v25, v18, v18 row_shr:1 row_mask:0xf bank_mask:0xf bound_ctrl:0
    v_cndmask_b32_e64 v19, v19, v17, s[20:21]
    s_nop 0
    v_max_u32_dpp v25, v25, v25 row_shr:2 row_mask:0xf bank_mask:0xf bound_ctrl:0
    s_nop 1
    v_max_u32_dpp v25, v25, v25 row_shr:4 row_mask:0xf bank_mask:0xf bound_ctrl:0
    s_nop 1
    v_max_u32_dpp v25, v25, v25 row_shr:8 row_mask:0xf bank_mask:0xf bound_ctrl:0
    s_nop 1
    v_max_u32_dpp v25, v25, v25 row_bcast:15 row_mask:0xa bank_mask:0xf
    s_nop 1
    v_max_u32_dpp v25, v25, v25 row_bcast:31 row_mask:0xc bank_mask:0xf
    s_nop 0
    v_readlane_b32 s44, v25, 63
    s_nop 1
    v_cmp_eq_u32_e64 s[20:21], s44, v18
    s_nop 1
    v_cndmask_b32_e64 v18, v18, v16, s[20:21]
    v_cndmask_b32_e64 v16, v16, v22, s[20:21]
    v_cndmask_b32_e64 v22, v22, v19, s[20:21]
    v_max_u32_dpp v25, v18, v18 row_shr:1 row_mask:0xf bank_mask:0xf bound_ctrl:0
    s_nop 1
    v_max_u32_dpp v25, v25, v25 row_shr:2 row_mask:0xf bank_mask:0xf bound_ctrl:0
    s_nop 1
    v_max_u32_dpp v25, v25, v25 row_shr:4 row_mask:0xf bank_mask:0xf bound_ctrl:0
    s_nop 1
    v_max_u32_dpp v25, v25, v25 row_shr:8 row_mask:0xf bank_mask:0xf bound_ctrl:0
    s_nop 1
    v_max_u32_dpp v25, v25, v25 row_bcast:15 row_mask:0xa bank_mask:0xf
    s_nop 1
    v_max_u32_dpp v25, v25, v25 row_bcast:31 row_mask:0xc bank_mask:0xf
    s_nop 0
    v_readlane_b32 s45, v25, 63
    s_nop 1
    v_cmp_eq_u32_e64 s[20:21], s45, v18
    s_nop 1
    v_cndmask_b32_e64 v18, v18, v16, s[20:21]
    v_cndmask_b32_e64 v16, v16, v22, s[20:21]
    s_nop 0
    v_max_u32_dpp v25, v18, v18 row_shr:1 row_mask:0xf bank_mask:0xf bound_ctrl:0
    s_nop 1
    v_max_u32_dpp v25, v25, v25 row_shr:2 row_mask:0xf bank_mask:0xf bound_ctrl:0
    s_nop 1
    v_max_u32_dpp v25, v25, v25 row_shr:4 row_mask:0xf bank_mask:0xf bound_ctrl:0
    s_nop 1
    v_max_u32_dpp v25, v25, v25 row_shr:8 row_mask:0xf bank_mask:0xf bound_ctrl:0
    s_nop 1
    v_max_u32_dpp v25, v25, v25 row_bcast:15 row_mask:0xa bank_mask:0xf
    s_nop 1
    v_max_u32_dpp v25, v25, v25 row_bcast:31 row_mask:0xc bank_mask:0xf
    s_nop 0
    v_readlane_b32 s46, v25, 63
    s_nop 1
    v_cmp_eq_u32_e64 s[20:21], s46, v18
    s_nop 1
    v_cndmask_b32_e64 v18, v18, v16, s[20:21]
    s_nop 1
    v_max_u32_dpp v25, v18, v18 row_shr:1 row_mask:0xf bank_mask:0xf bound_ctrl:0
    s_nop 1
    v_max_u32_dpp v25, v25, v25 row_shr:2 row_mask:0xf bank_mask:0xf bound_ctrl:0
    s_nop 1
    v_max_u32_dpp v25, v25, v25 row_shr:4 row_mask:0xf bank_mask:0xf bound_ctrl:0
    s_nop 1
    v_max_u32_dpp v25, v25, v25 row_shr:8 row_mask:0xf bank_mask:0xf bound_ctrl:0
    s_nop 1
    v_max_u32_dpp v25, v25, v25 row_bcast:15 row_mask:0xa bank_mask:0xf
    s_nop 1
    v_max_u32_dpp v25, v25, v25 row_bcast:31 row_mask:0xc bank_mask:0xf
    s_nop 0
    v_readlane_b32 s47, v25, 63
    v_mov_b32 v28, s40
    v_mov_b32 v29, s41
    v_mov_b32 v30, s42
    v_mov_b32 v31, s43
    v_mov_b32 v32, s44
    v_mov_b32 v33, s45
    v_mov_b32 v34, s46
    v_mov_b32 v35, s47
    v_lshlrev_b32 v25, 5, v2
    v_cmp_eq_u32 vcc, 0, v1
    s_and_saveexec_b64 s[20:21], vcc
    ds_write_b128 v25, v[28:31] offset:25600
    ds_write_b128 v25, v[32:35] offset:25616
    s_mov_b64 exec, s[20:21]
    v_and_b32 v25, 31, v1
    v_lshlrev_b32 v25, 2, v25
    v_mov_b32 v27, 0
    s_waitcnt lgkmcnt(0)
    s_barrier
    ds_read_b32 v26, v25 offset:25600
    ds_read_b128 v[36:39], v27 offset:25600
    ds_read_b128 v[40:43], v27 offset:25616
    ds_read_b128 v[44:47], v27 offset:25632
    ds_read_b128 v[48:51], v27 offset:25648
    ds_read_b128 v[52:55], v27 offset:25664
    ds_read_b128 v[56:59], v27 offset:25680
    ds_read_b128 v[60:63], v27 offset:25696
    ds_read_b128 v[64:67], v27 offset:25712
    s_waitcnt lgkmcnt(0)
    v_mov_b32 v16, 0
    v_mov_b32 v17, 0
    v_mov_b32 v18, 0
    v_mov_b32 v19, 0
    v_cmp_gt_u32_e64 s[22:23], v36, v26
    v_cmp_gt_u32_e64 s[24:25], v37, v26
    v_cmp_gt_u32_e64 s[26:27], v38, v26
    v_cmp_gt_u32_e64 s[28:29], v39, v26
    v_addc_co_u32_e64 v16, s[22:23], 0, v16, s[22:23]
    v_addc_co_u32_e64 v17, s[24:25], 0, v17, s[24:25]
    v_addc_co_u32_e64 v18, s[26:27], 0, v18, s[26:27]
    v_addc_co_u32_e64 v19, s[28:29], 0, v19, s[28:29]
    v_cmp_gt_u32_e64 s[22:23], v40, v26
    v_cmp_gt_u32_e64 s[24:25], v41, v26
    v_cmp_gt_u32_e64 s[26:27], v42, v26
    v_cmp_gt_u32_e64 s[28:29], v43, v26
    v_addc_co_u32_e64 v16, s[22:23], 0, v16, s[22:23]
    v_addc_co_u32_e64 v17, s[24:25], 0, v17, s[24:25]
    v_addc_co_u32_e64 v18, s[26:27], 0, v18, s[26:27]
    v_addc_co_u32_e64 v19, s[28:29], 0, v19, s[28:29]
    v_cmp_gt_u32_e64 s[22:23], v44, v26
    v_cmp_gt_u32_e64 s[24:25], v45, v26
    v_cmp_gt_u32_e64 s[26:27], v46, v26
    v_cmp_gt_u32_e64 s[28:29], v47, v26
    v_addc_co_u32_e64 v16, s[22:23], 0, v16, s[22:23]
    v_addc_co_u32_e64 v17, s[24:25], 0, v17, s[24:25]
    v_addc_co_u32_e64 v18, s[26:27], 0, v18, s[26:27]
    v_addc_co_u32_e64 v19, s[28:29], 0, v19, s[28:29]
    v_cmp_gt_u32_e64 s[22:23], v48, v26
    v_cmp_gt_u32_e64 s[24:25], v49, v26
    v_cmp_gt_u32_e64 s[26:27], v50, v26
    v_cmp_gt_u32_e64 s[28:29], v51, v26
    v_addc_co_u32_e64 v16, s[22:23], 0, v16, s[22:23]
    v_addc_co_u32_e64 v17, s[24:25], 0, v17, s[24:25]
    v_addc_co_u32_e64 v18, s[26:27], 0, v18, s[26:27]
    v_addc_co_u32_e64 v19, s[28:29], 0, v19, s[28:29]
    v_cmp_gt_u32_e64 s[22:23], v52, v26
    v_cmp_gt_u32_e64 s[24:25], v53, v26
    v_cmp_gt_u32_e64 s[26:27], v54, v26
    v_cmp_gt_u32_e64 s[28:29], v55, v26
    v_addc_co_u32_e64 v16, s[22:23], 0, v16, s[22:23]
    v_addc_co_u32_e64 v17, s[24:25], 0, v17, s[24:25]
    v_addc_co_u32_e64 v18, s[26:27], 0, v18, s[26:27]
    v_addc_co_u32_e64 v19, s[28:29], 0, v19, s[28:29]
    v_cmp_gt_u32_e64 s[22:23], v56, v26
    v_cmp_gt_u32_e64 s[24:25], v57, v26
    v_cmp_gt_u32_e64 s[26:27], v58, v26
    v_cmp_gt_u32_e64 s[28:29], v59, v26
    v_addc_co_u32_e64 v16, s[22:23], 0, v16, s[22:23]
    v_addc_co_u32_e64 v17, s[24:25], 0, v17, s[24:25]
    v_addc_co_u32_e64 v18, s[26:27], 0, v18, s[26:27]
    v_addc_co_u32_e64 v19, s[28:29], 0, v19, s[28:29]
    v_cmp_gt_u32_e64 s[22:23], v60, v26
    v_cmp_gt_u32_e64 s[24:25], v61, v26
    v_cmp_gt_u32_e64 s[26:27], v62, v26
    v_cmp_gt_u32_e64 s[28:29], v63, v26
    v_addc_co_u32_e64 v16, s[22:23], 0, v16, s[22:23]
    v_addc_co_u32_e64 v17, s[24:25], 0, v17, s[24:25]
    v_addc_co_u32_e64 v18, s[26:27], 0, v18, s[26:27]
    v_addc_co_u32_e64 v19, s[28:29], 0, v19, s[28:29]
    v_cmp_gt_u32_e64 s[22:23], v64, v26
    v_cmp_gt_u32_e64 s[24:25], v65, v26
    v_cmp_gt_u32_e64 s[26:27], v66, v26
    v_cmp_gt_u32_e64 s[28:29], v67, v26
    v_addc_co_u32_e64 v16, s[22:23], 0, v16, s[22:23]
    v_addc_co_u32_e64 v17, s[24:25], 0, v17, s[24:25]
    v_addc_co_u32_e64 v18, s[26:27], 0, v18, s[26:27]
    v_addc_co_u32_e64 v19, s[28:29], 0, v19, s[28:29]
    v_add_u32 v16, v16, v17
    v_add_u32 v18, v18, v19
    v_add_u32 v16, v16, v18
    v_cmp_eq_u32_e64 s[22:23], 0, v16
    v_cmp_eq_u32_e64 s[24:25], 1, v16
    v_cmp_eq_u32_e64 s[26:27], 2, v16
    v_cmp_eq_u32_e64 s[28:29], 3, v16
    s_ff1_i32_b32 s22, s22
    s_ff1_i32_b32 s24, s24
    s_ff1_i32_b32 s26, s26
    s_ff1_i32_b32 s28, s28
    v_readlane_b32 s40, v26, s22
    v_readlane_b32 s41, v26, s24
    v_readlane_b32 s42, v26, s26
    v_readlane_b32 s43, v26, s28
    v_cmp_eq_u32_e64 s[22:23], 4, v16
    v_cmp_eq_u32_e64 s[24:25], 5, v16
    v_cmp_eq_u32_e64 s[26:27], 6, v16
    v_cmp_eq_u32_e64 s[28:29], 7, v16
    s_ff1_i32_b32 s22, s22
    s_ff1_i32_b32 s24, s24
    s_ff1_i32_b32 s26, s26
    s_ff1_i32_b32 s28, s28
    v_readlane_b32 s44, v26, s22
    v_readlane_b32 s45, v26, s24
    v_readlane_b32 s46, v26, s26
    v_readlane_b32 s47, v26, s28
    v_and_b32 v5, 7, v1
    v_mov_b32 v6, 0
    s_and_b32 s20, s40, 0xffff
    s_sub_u32 s20, 2047, s20
    s_mul_i32 s20, s20, 896
    v_cmp_eq_u32_e64 s[34:35], 0, v5
    v_mov_b32 v7, s20
    s_nop 0
    v_cndmask_b32_e64 v6, v6, v7, s[34:35]
    s_and_b32 s20, s41, 0xffff
    s_sub_u32 s20, 2047, s20
    s_mul_i32 s20, s20, 896
    v_cmp_eq_u32_e64 s[34:35], 1, v5
    v_mov_b32 v7, s20
    s_nop 0
    v_cndmask_b32_e64 v6, v6, v7, s[34:35]
    s_and_b32 s20, s42, 0xffff
    s_sub_u32 s20, 2047, s20
    s_mul_i32 s20, s20, 896
    v_cmp_eq_u32_e64 s[34:35], 2, v5
    v_mov_b32 v7, s20
    s_nop 0
    v_cndmask_b32_e64 v6, v6, v7, s[34:35]
    s_and_b32 s20, s43, 0xffff
    s_sub_u32 s20, 2047, s20
    s_mul_i32 s20, s20, 896
    v_cmp_eq_u32_e64 s[34:35], 3, v5
    v_mov_b32 v7, s20
    s_nop 0
    v_cndmask_b32_e64 v6, v6, v7, s[34:35]
    s_and_b32 s20, s44, 0xffff
    s_sub_u32 s20, 2047, s20
    s_mul_i32 s20, s20, 896
    v_cmp_eq_u32_e64 s[34:35], 4, v5
    v_mov_b32 v7, s20
    s_nop 0
    v_cndmask_b32_e64 v6, v6, v7, s[34:35]
    s_and_b32 s20, s45, 0xffff
    s_sub_u32 s20, 2047, s20
    s_mul_i32 s20, s20, 896
    v_cmp_eq_u32_e64 s[34:35], 5, v5
    v_mov_b32 v7, s20
    s_nop 0
    v_cndmask_b32_e64 v6, v6, v7, s[34:35]
    s_and_b32 s20, s46, 0xffff
    s_sub_u32 s20, 2047, s20
    s_mul_i32 s20, s20, 896
    v_cmp_eq_u32_e64 s[34:35], 6, v5
    v_mov_b32 v7, s20
    s_nop 0
    v_cndmask_b32_e64 v6, v6, v7, s[34:35]
    s_and_b32 s20, s47, 0xffff
    s_sub_u32 s20, 2047, s20
    s_mul_i32 s20, s20, 896
    v_cmp_eq_u32_e64 s[34:35], 7, v5
    v_mov_b32 v7, s20
    s_nop 0
    v_cndmask_b32_e64 v6, v6, v7, s[34:35]
    v_lshrrev_b32 v7, 4, v1
    v_lshl_add_u32 v6, v7, 4, v6
    v_lshl_add_u32 v6, v2, 6, v6
    s_mov_b32 s19, 6291456
    buffer_load_dwordx4 v[16:19], v6, s[4:7], s19 offen offset:0
    buffer_load_dwordx4 v[20:23], v6, s[4:7], s19 offen offset:256
    buffer_load_dwordx4 v[24:27], v6, s[4:7], s19 offen offset:512
    buffer_load_dwordx4 v[28:31], v6, s[4:7], s19 offen offset:768
    s_cmp_lg_u32 s2, 0
    s_cbranch_scc1 L4_nokeys
    v_mov_b32 v64, s40
    v_mov_b32 v65, s41
    v_mov_b32 v66, s42
    v_mov_b32 v67, s43
    v_mov_b32 v68, s44
    v_mov_b32 v69, s45
    v_mov_b32 v70, s46
    v_mov_b32 v71, s47
    v_mov_b32 v72, 0
    s_mov_b32 s19, 8454144
    v_cmp_eq_u32 vcc, 0, v0
    s_and_saveexec_b64 s[20:21], vcc
    buffer_store_dwordx4 v[64:67], v72, s[4:7], s19 offen
    buffer_store_dwordx4 v[68:71], v72, s[4:7], s19 offen offset:16
    s_mov_b64 exec, s[20:21]
L4_nokeys:
    s_nop 1
    v_and_b32 v8, 3, v1
    v_bfe_u32 v9, v1, 2, 2
    v_lshl_add_u32 v9, v7, 3, v9
    v_lshlrev_b32 v9, 5, v9
    v_lshl_add_u32 v9, v8, 3, v9
    v_lshl_add_u32 v9, v2, 10, v9
    v_mov_b32 v60, 0
    v_mov_b32 v61, 0
    v_mov_b32 v62, 0
    v_mov_b32 v63, 0
    v_and_b32 v11, 1, v7
    v_bfe_u32 v12, v1, 2, 2
    v_lshl_add_u32 v11, v11, 2, v12
    v_mul_u32_u24 v11, 896, v11
    v_lshl_add_u32 v11, v8, 3, v11
    v_mul_u32_u24 v12, 224, v2
    v_add_u32 v11, v11, v12
    s_barrier
    ds_read_b64_tr_b16 v[32:33], v9 offset:0
    ds_read_b64_tr_b16 v[34:35], v9 offset:128
    ds_read_b64_tr_b16 v[36:37], v9 offset:4096
    ds_read_b64_tr_b16 v[38:39], v9 offset:4224
    ds_read_b64_tr_b16 v[40:41], v9 offset:8192
    ds_read_b64_tr_b16 v[42:43], v9 offset:8320
    ds_read_b64_tr_b16 v[44:45], v9 offset:12288
    ds_read_b64_tr_b16 v[46:47], v9 offset:12416
    s_waitcnt vmcnt(0)
    s_waitcnt lgkmcnt(6)
    v_mfma_f32_16x16x32_bf16 v[60:63], v[32:35], v[16:19], v[60:63]
    s_waitcnt lgkmcnt(4)
    v_mfma_f32_16x16x32_bf16 v[60:63], v[36:39], v[20:23], v[60:63]
    s_waitcnt lgkmcnt(2)
    v_mfma_f32_16x16x32_bf16 v[60:63], v[40:43], v[24:27], v[60:63]
    s_cmp_ge_u32 s18, 2
    s_cbranch_scc1 L4_mmdone
    s_waitcnt lgkmcnt(0)
    v_mfma_f32_16x16x32_bf16 v[60:63], v[44:47], v[28:31], v[60:63]
L4_mmdone:
    ds_read_b64_tr_b16 v[76:77], v11 offset:14336
    ds_read_b64_tr_b16 v[78:79], v11 offset:14368
    ds_read_b64_tr_b16 v[80:81], v11 offset:14400
    ds_read_b64_tr_b16 v[82:83], v11 offset:14432
    ds_read_b64_tr_b16 v[84:85], v11 offset:14464
    ds_read_b64_tr_b16 v[86:87], v11 offset:14496
    ds_read_b64_tr_b16 v[88:89], v11 offset:14528
    v_lshlrev_b32 v13, 4, v1
    ds_write_b128 v10, v[60:63] offset:21504
    v_and_b32 v5, 15, v1
    v_mul_u32_u24 v15, 28, v5
    v_mul_u32_u24 v12, 7, v2
    v_add_u32 v15, v15, v12
    v_mul_u32_u24 v15, 14336, v15
    v_lshl_add_u32 v15, v7, 4, v15
    s_lshl_b32 s19, s16, 6
    s_add_u32 s19, s19, 9437184
    v_mov_b32 v30, 0
    v_mov_b32 v31, 0
    s_waitcnt lgkmcnt(0)
    s_barrier
    ds_read_b128 v[16:19], v13 offset:21504
    ds_read_b128 v[20:23], v13 offset:22528
    ds_read_b128 v[24:27], v13 offset:23552
    ds_read_b128 v[32:35], v13 offset:24576
    s_waitcnt lgkmcnt(0)
    v_pk_add_f32 v[16:17], v[16:17], v[20:21]
    v_pk_add_f32 v[18:19], v[18:19], v[22:23]
    v_pk_add_f32 v[24:25], v[24:25], v[32:33]
    v_pk_add_f32 v[26:27], v[26:27], v[34:35]
    v_pk_add_f32 v[16:17], v[16:17], v[24:25]
    v_pk_add_f32 v[18:19], v[18:19], v[26:27]
    v_cvt_pk_bf16_f32 v36, v16, v17
    v_lshlrev_b32 v16, 16, v36
    v_and_b32 v17, 0xffff0000, v36
    v_cvt_pk_bf16_f32 v37, v18, v19
    v_lshlrev_b32 v18, 16, v37
    v_and_b32 v19, 0xffff0000, v37
    v_max_f32 v44, 0xc2ae0000, v16
    v_max_f32 v45, 0xc2ae0000, v17
    v_max_f32 v46, 0xc2ae0000, v18
    v_max_f32 v47, 0xc2ae0000, v19
    v_min_f32 v44, 0x42ae0000, v44
    v_min_f32 v45, 0x42ae0000, v45
    v_min_f32 v46, 0x42ae0000, v46
    v_min_f32 v47, 0x42ae0000, v47
    v_mul_f32 v64, s30, v44
    v_mul_f32 v65, s30, v45
    v_mul_f32 v66, s30, v46
    v_mul_f32 v67, s30, v47
    v_mov_b32 v40, v16
    v_mov_b32 v41, v17
    v_mov_b32 v42, v18
    v_mov_b32 v43, v19
    v_fma_f32 v68, v44, s30, -v64
    v_fma_f32 v69, v45, s30, -v65
    v_fma_f32 v70, v46, s30, -v66
    v_fma_f32 v71, v47, s30, -v67
    v_exp_f32_e64 v64, -v64
    v_exp_f32_e64 v65, -v65
    v_exp_f32_e64 v66, -v66
    v_exp_f32_e64 v67, -v67
    v_fma_f32 v68, v44, s31, v68
    v_fma_f32 v69, v45, s31, v69
    v_fma_f32 v70, v46, s31, v70
    v_fma_f32 v71, v47, s31, v71
    v_permlane32_swap_b32 v40, v24
    v_permlane32_swap_b32 v41, v25
    v_permlane32_swap_b32 v42, v26
    v_permlane32_swap_b32 v43, v27
    v_mul_f32 v68, s32, v68
    v_mul_f32 v69, s32, v69
    v_mul_f32 v70, s32, v70
    v_mul_f32 v71, s32, v71
    v_fma_f32 v64, v64, -v68, v64
    v_fma_f32 v65, v65, -v69, v65
    v_fma_f32 v66, v66, -v70, v66
    v_fma_f32 v67, v67, -v71, v67
    v_add_f32 v64, 1.0, v64
    v_add_f32 v65, 1.0, v65
    v_add_f32 v66, 1.0, v66
    v_add_f32 v67, 1.0, v67
    v_rcp_f32 v68, v64
    v_rcp_f32 v69, v65
    v_rcp_f32 v70, v66
    v_rcp_f32 v71, v67
    v_mul_f32 v20, v16, v68
    v_mul_f32 v21, v17, v69
    v_mul_f32 v22, v18, v70
    v_mul_f32 v23, v19, v71
    v_fma_f32 v72, -v20, v64, v16
    v_fma_f32 v73, -v21, v65, v17
    v_fma_f32 v74, -v22, v66, v18
    v_fma_f32 v75, -v23, v67, v19
    v_fma_f32 v20, v72, v68, v20
    v_fma_f32 v21, v73, v69, v21
    v_fma_f32 v22, v74, v70, v22
    v_fma_f32 v23, v75, v71, v23
    v_cvt_pk_bf16_f32 v36, v20, v21
    v_lshlrev_b32 v20, 16, v36
    v_and_b32 v21, 0xffff0000, v36
    v_cvt_pk_bf16_f32 v37, v22, v23
    v_lshlrev_b32 v22, 16, v37
    v_and_b32 v23, 0xffff0000, v37
    v_pk_mul_f32 v[20:21], v[20:21], v[24:25]
    v_pk_mul_f32 v[22:23], v[22:23], v[26:27]
    s_mov_b32 exec_lo, 0x00ff00ff
    s_mov_b32 exec_hi, 0
    v_cvt_pk_bf16_f32 v30, v20, v21
    v_cvt_pk_bf16_f32 v31, v22, v23
    s_mov_b64 exec, -1
    s_nop 0
    v_mfma_f32_16x16x16_bf16 v[32:35], v[76:77], v[30:31], 0
    v_mfma_f32_16x16x16_bf16 v[36:39], v[78:79], v[30:31], 0
    v_mfma_f32_16x16x16_bf16 v[40:43], v[80:81], v[30:31], 0
    v_mfma_f32_16x16x16_bf16 v[44:47], v[82:83], v[30:31], 0
    v_mfma_f32_16x16x16_bf16 v[48:51], v[84:85], v[30:31], 0
    v_mfma_f32_16x16x16_bf16 v[52:55], v[86:87], v[30:31], 0
    v_mfma_f32_16x16x16_bf16 v[56:59], v[88:89], v[30:31], 0
    s_mov_b32 exec_lo, 0x00ff00ff
    s_mov_b32 exec_hi, 0x00ff00ff
    buffer_store_dwordx4 v[32:35], v15, s[4:7], s19 offen sc1
    s_add_u32 s19, s19, 14336
    buffer_store_dwordx4 v[36:39], v15, s[4:7], s19 offen sc1
    s_add_u32 s19, s19, 14336
    buffer_store_dwordx4 v[40:43], v15, s[4:7], s19 offen sc1
    s_add_u32 s19, s19, 14336
    buffer_store_dwordx4 v[44:47], v15, s[4:7], s19 offen sc1
    s_add_u32 s19, s19, 14336
    buffer_store_dwordx4 v[48:51], v15, s[4:7], s19 offen sc1
    s_add_u32 s19, s19, 14336
    buffer_store_dwordx4 v[52:55], v15, s[4:7], s19 offen sc1
    s_add_u32 s19, s19, 14336
    buffer_store_dwordx4 v[56:59], v15, s[4:7], s19 offen sc1
L4_end:
    s_endpgm
.globl k5_kernel
.p2align 8
.type k5_kernel,@function
k5_kernel:
    s_cmp_ge_u32 s2, 224
    s_cbranch_scc1 L5_end
    s_load_dwordx2 s[4:5], s[0:1], 144
    s_mov_b32 s6, 268435456
    s_mov_b32 s7, 0x20000
    s_load_dwordx2 s[12:13], s[0:1], 128
    s_mov_b32 s14, 1835008
    s_mov_b32 s15, 0x20000
    s_mov_b32 s30, 0x3fb8aa3b
    s_mov_b32 s31, 0x32a57060
    s_mov_b32 s32, 0x3f317218
    s_mul_hi_u32 s16, s2, 153391690
    s_mul_i32 s17, s16, 28
    s_sub_u32 s17, s2, s17
    v_lshlrev_b32 v4, 4, v0
    s_mul_i32 s19, s2, 14336
    s_add_u32 s19, s19, 9437184
    s_lshl_b32 s20, s16, 2
    s_add_u32 s20, s20, 8454144
    v_mov_b32 v5, 0
    v_mov_b32 v12, 0
    v_mov_b32 v28, 0
    v_mov_b32 v29, 0
    v_mov_b32 v30, 0
    v_mov_b32 v31, 0
    s_waitcnt lgkmcnt(0)
    buffer_load_dword v40, v5, s[4:7], s20 offen
    buffer_load_dwordx4 v[16:19], v4, s[4:7], s19 offen
    s_add_u32 s19, s19, 4096
    buffer_load_dwordx4 v[20:23], v4, s[4:7], s19 offen
    s_add_u32 s19, s19, 4096
    buffer_load_dwordx4 v[24:27], v4, s[4:7], s19 offen
    s_add_u32 s19, s19, 4096
    v_cmp_gt_u32 vcc, 128, v0
    s_and_saveexec_b64 s[22:23], vcc
    s_cbranch_execz L5_skip
    buffer_load_dwordx4 v[28:31], v4, s[4:7], s19 offen
L5_skip:
    s_mov_b64 exec, s[22:23]
    v_and_b32 v6, 15, v0
    v_lshlrev_b32 v7, 2, v6
    s_lshl_b32 s21, s17, 6
    s_add_u32 s21, s21, 8960
    buffer_load_dword v41, v7, s[4:7], s21 offen
    v_readfirstlane_b32 s24, v0
    s_cmp_lg_u32 s24, 0
    s_cbranch_scc1 L5_nogather
    s_waitcnt vmcnt(5)
    v_and_b32 v8, 0xffff, v40
    v_sub_u32 v8, 2047, v8
    s_lshl_b32 s25, s17, 4
    v_add_u32 v9, s25, v6
    s_mov_b32 s26, 2097152
    s_mov_b32 s27, 6291456
    v_mul_u32_u24 v12, 896, v8
    v_lshl_add_u32 v12, v9, 1, v12
    buffer_load_ushort v42, v12, s[4:7], s26 offen
    buffer_load_ushort v43, v12, s[4:7], s27 offen
    v_lshrrev_b32 v33, 16, v40
    v_bfe_i32 v34, v33, 15, 1
    v_not_b32 v34, v34
    v_or_b32 v34, 0x8000, v34
    v_xor_b32 v33, v33, v34
    v_lshlrev_b32 v33, 16, v33
    v_max_f32 v33, 0xc2ae0000, v33
    v_min_f32 v33, 0x42ae0000, v33
    v_mul_f32 v35, s30, v33
    v_fma_f32 v36, v33, s30, -v35
    v_fma_f32 v36, v33, s31, v36
    v_exp_f32_e64 v34, -v35
    v_mul_f32 v36, s32, v36
    v_fma_f32 v34, v34, -v36, v34
    v_add_f32 v34, 1.0, v34
    v_rcp_f32 v35, v34
    v_mov_b32 v37, 1.0
    v_mul_f32 v44, v37, v35
    v_fma_f32 v36, -v44, v34, v37
    v_fma_f32 v44, v36, v35, v44
    v_cvt_pk_bf16_f32 v35, v44, v44
    v_lshlrev_b32 v44, 16, v35
    s_waitcnt vmcnt(3)
    s_branch L5_sum
L5_nogather:
    s_waitcnt vmcnt(1)
L5_sum:
    v_add_f32 v16, v16, v20
    v_add_f32 v24, v24, v28
    v_add_f32 v16, v16, v24
    v_add_f32 v17, v17, v21
    v_add_f32 v25, v25, v29
    v_add_f32 v17, v17, v25
    v_add_f32 v18, v18, v22
    v_add_f32 v26, v26, v30
    v_add_f32 v18, v18, v26
    v_add_f32 v19, v19, v23
    v_add_f32 v27, v27, v31
    v_add_f32 v19, v19, v27
    v_add_f32_dpp v16, v16, v16 row_ror:4 row_mask:0xf bank_mask:0xf
    v_add_f32_dpp v17, v17, v17 row_ror:4 row_mask:0xf bank_mask:0xf
    v_add_f32_dpp v18, v18, v18 row_ror:4 row_mask:0xf bank_mask:0xf
    v_add_f32_dpp v19, v19, v19 row_ror:4 row_mask:0xf bank_mask:0xf
    v_add_f32_dpp v16, v16, v16 row_ror:8 row_mask:0xf bank_mask:0xf
    v_add_f32_dpp v17, v17, v17 row_ror:8 row_mask:0xf bank_mask:0xf
    v_add_f32_dpp v18, v18, v18 row_ror:8 row_mask:0xf bank_mask:0xf
    v_add_f32_dpp v19, v19, v19 row_ror:8 row_mask:0xf bank_mask:0xf
    v_lshrrev_b32 v13, 4, v0
    v_lshlrev_b32 v13, 6, v13
    v_and_b32 v14, 3, v0
    v_lshl_add_u32 v13, v14, 4, v13
    v_and_b32 v14, 12, v0
    v_cmp_eq_u32 vcc, 0, v14
    s_and_saveexec_b64 s[22:23], vcc
    ds_write_b128 v13, v[16:19]
    s_mov_b64 exec, s[22:23]
    s_waitcnt lgkmcnt(0)
    s_barrier
    s_cmp_lg_u32 s24, 0
    s_cbranch_scc1 L5_end
    ds_read_b32 v48, v7 offset:0
    ds_read_b32 v49, v7 offset:64
    ds_read_b32 v50, v7 offset:128
    ds_read_b32 v51, v7 offset:192
    ds_read_b32 v52, v7 offset:256
    ds_read_b32 v53, v7 offset:320
    ds_read_b32 v54, v7 offset:384
    ds_read_b32 v55, v7 offset:448
    ds_read_b32 v56, v7 offset:512
    ds_read_b32 v57, v7 offset:576
    ds_read_b32 v58, v7 offset:640
    ds_read_b32 v59, v7 offset:704
    ds_read_b32 v60, v7 offset:768
    ds_read_b32 v61, v7 offset:832
    ds_read_b32 v62, v7 offset:896
    ds_read_b32 v63, v7 offset:960
    s_waitcnt lgkmcnt(0) vmcnt(0)
    v_add_f32 v48, v48, v56
    v_add_f32 v49, v49, v57
    v_add_f32 v50, v50, v58
    v_add_f32 v51, v51, v59
    v_add_f32 v52, v52, v60
    v_add_f32 v53, v53, v61
    v_add_f32 v54, v54, v62
    v_add_f32 v55, v55, v63
    v_add_f32 v48, v48, v52
    v_add_f32 v49, v49, v53
    v_add_f32 v50, v50, v54
    v_add_f32 v51, v51, v55
    v_add_f32 v48, v48, v50
    v_add_f32 v49, v49, v51
    v_add_f32 v48, v48, v49
    v_cvt_pk_bf16_f32 v35, v48, v48
    v_lshlrev_b32 v48, 16, v35
    v_mul_f32 v48, v48, v44
    v_cvt_pk_bf16_f32 v35, v48, v48
    v_lshlrev_b32 v48, 16, v35
    v_lshlrev_b32 v42, 16, v42
    v_lshlrev_b32 v43, 16, v43
    v_add_f32 v48, v48, v43
    v_cvt_pk_bf16_f32 v35, v48, v48
    v_lshlrev_b32 v48, 16, v35
    v_mul_f32 v48, v48, v41
    v_cvt_pk_bf16_f32 v35, v48, v48
    v_lshlrev_b32 v48, 16, v35
    v_add_f32 v48, v48, v42
    v_cvt_pk_bf16_f32 v48, v48, v48
    s_mov_b32 exec_lo, 0xffff
    s_mov_b32 exec_hi, 0
    buffer_store_short v48, v12, s[12:15], 0 offen
L5_end:
    s_endpgm
CODE_END:
.section .rodata,"a"
.p2align 6
.amdhsa_kernel f1_kernel
  .amdhsa_next_free_vgpr 160
  .amdhsa_next_free_sgpr 102
  .amdhsa_accum_offset 160
  .amdhsa_group_segment_fixed_size 0
  .amdhsa_kernarg_size 152
  .amdhsa_user_sgpr_count 2
  .amdhsa_user_sgpr_kernarg_segment_ptr 1
  .amdhsa_system_sgpr_workgroup_id_x 1
  .amdhsa_float_denorm_mode_32 3
.end_amdhsa_kernel
.p2align 6
.amdhsa_kernel k3_kernel
  .amdhsa_next_free_vgpr 128
  .amdhsa_next_free_sgpr 102
  .amdhsa_accum_offset 128
  .amdhsa_group_segment_fixed_size 0
  .amdhsa_kernarg_size 152
  .amdhsa_user_sgpr_count 2
  .amdhsa_user_sgpr_kernarg_segment_ptr 1
  .amdhsa_system_sgpr_workgroup_id_x 1
  .amdhsa_float_denorm_mode_32 3
.end_amdhsa_kernel
.p2align 6
.amdhsa_kernel k4_kernel
  .amdhsa_next_free_vgpr 96
  .amdhsa_next_free_sgpr 102
  .amdhsa_accum_offset 96
  .amdhsa_group_segment_fixed_size 0
  .amdhsa_kernarg_size 152
  .amdhsa_user_sgpr_count 2
  .amdhsa_user_sgpr_kernarg_segment_ptr 1
  .amdhsa_system_sgpr_workgroup_id_x 1
  .amdhsa_float_denorm_mode_32 3
.end_amdhsa_kernel
.p2align 6
.amdhsa_kernel k5_kernel
  .amdhsa_next_free_vgpr 64
  .amdhsa_next_free_sgpr 102
  .amdhsa_accum_offset 64
  .amdhsa_group_segment_fixed_size 0
  .amdhsa_kernarg_size 152
  .amdhsa_user_sgpr_count 2
  .amdhsa_user_sgpr_kernarg_segment_ptr 1
  .amdhsa_system_sgpr_workgroup_id_x 1
  .amdhsa_float_denorm_mode_32 3
.end_amdhsa_kernel
```
